```python
import torch

def _softmax(x, axis=-1):
    return torch.softmax(x, dim=axis)
def _gelu(x):
    return torch.nn.functional.gelu(x, approximate="tanh")
def _silu(x):
    return torch.nn.functional.silu(x)
def _sigmoid(x):
    return torch.sigmoid(x)
def _layernorm(x, axis=-1, eps=1e-5):
    m = x.mean(dim=axis, keepdim=True)
    v = x.var(dim=axis, keepdim=True, unbiased=False)
    return (x - m) / torch.sqrt(v + eps)
def _scatter_add(tgt, idx, src, axis=0):
    return tgt.clone().index_add_(axis, idx, src)
def _segment_sum(src, seg, n):
    out = torch.zeros((n,) + src.shape[1:], dtype=src.dtype)
    return out.index_add_(0, seg, src)
def _pad(x, pw):
    flat = tuple(v for pair in reversed(pw) for v in pair)
    return torch.nn.functional.pad(x, flat)

kernel_name = 'concat_heads__linear_attn_block__ssm_conv_s4__prompt'

def setup_inputs():

    _w = (lambda a: (lambda t: t.to(torch.bfloat16) if t.is_floating_point() else t)(torch.as_tensor(a)))
    def _A_setup():
        B, S, D = 1, 2048, 1024
        return {
            "x": _w((lambda *s: torch.randn(*s, dtype=torch.bfloat16) * 0.05)(B, S, D)),
            "wqkv": _w((lambda *s: torch.randn(*s, dtype=torch.bfloat16) * 0.8)(D, 3 * D)),
            "wo": _w((lambda *s: torch.randn(*s, dtype=torch.bfloat16) * 0.05)(D, D)),
        }
    _A_in = _A_setup()

    def _B_setup():
        B, L, D, N = 1, 2048, 1024, 128
        A_re = -(lambda _x: torch.exp(torch.as_tensor(_x)))((lambda *s: torch.randn(*s, dtype=torch.bfloat16) * 6.4)(D, N))
        A_im = torch.pi * (lambda *s: torch.randn(*s, dtype=torch.bfloat16) * 0.05)(D, N)
        B_re = (lambda *s: torch.randn(*s, dtype=torch.bfloat16) * 0.2)(D, N)
        B_im = (lambda *s: torch.randn(*s, dtype=torch.bfloat16) * 0.2)(D, N)
        C_re = (lambda *s: torch.randn(*s, dtype=torch.bfloat16) * 0.2)(D, N)
        C_im = (lambda *s: torch.randn(*s, dtype=torch.bfloat16) * 0.2)(D, N)
        log_dt = (lambda *s: torch.randn(*s, dtype=torch.bfloat16) * 0.05)(D) * 0.5 - 4.0
        Dskip = (lambda *s: torch.randn(*s, dtype=torch.bfloat16) * 0.05)(D)
        return {
            "u": _w((lambda *s: torch.randn(*s, dtype=torch.bfloat16) * 0.05)(B, L, D)),
            "A_re": _w(A_re),
            "A_im": _w(A_im),
            "B_re": _w(B_re),
            "B_im": _w(B_im),
            "C_re": _w(C_re),
            "C_im": _w(C_im),
            "log_dt": _w(log_dt),
            "Dskip": _w(Dskip),
        }
    _B_in = _B_setup()

    return {
        "A_x": _A_in["x"],
        "A_wqkv": _A_in["wqkv"],
        "A_wo": _A_in["wo"],
        "B_u": _B_in["u"],
        "B_A_re": _B_in["A_re"],
        "B_A_im": _B_in["A_im"],
        "B_B_re": _B_in["B_re"],
        "B_B_im": _B_in["B_im"],
        "B_C_re": _B_in["C_re"],
        "B_C_im": _B_in["C_im"],
        "B_log_dt": _B_in["log_dt"],
        "B_Dskip": _B_in["Dskip"],
    }

def reference(A_x, A_wqkv, A_wo, B_u, B_A_re, B_A_im, B_B_re, B_B_im, B_C_re, B_C_im, B_log_dt, B_Dskip):
    def _A_ref(x, wqkv, wo):
        B, S, D = x.shape
        H = 32; Dh = D // H
        qkv = (lambda x, *d: x.permute(*d))((x @ wqkv).reshape(B, S, 3, H, Dh), 2, 0, 3, 1, 4)
        q, k, v = qkv[0], qkv[1], qkv[2]
        phi = lambda t: torch.where(t > 0, t + 1, torch.exp(t)) + 1e-6
        pq, pk = phi(q), phi(k)
        kv = torch.einsum("bhsd,bhse->bhde", pk, v)
        z = torch.einsum("bhsd->bhd", pk)
        num = torch.einsum("bhqd,bhde->bhqe", pq, kv)
        den = torch.einsum("bhqd,bhd->bhq", pq, z)[..., None] + 1e-6
        o = num / den
        return (lambda x, *d: x.permute(*d))(o, 0, 2, 1, 3).reshape(B, S, D) @ wo

    def _B_ref(u, A_re, A_im, B_re, B_im, C_re, C_im, log_dt, Dskip):
        Bsz, L, D = u.shape
        dt = torch.exp(log_dt)[:, None]
        A = A_re + 1j * A_im
        Bc = B_re + 1j * B_im
        Cc = C_re + 1j * C_im
        logdA = dt * A
        dB = dt * Bc
        l = (lambda x, dt: x.to(dt))(torch.arange(L), A_re.dtype)
        P = torch.exp(logdA[:, :, None] * l[None, None, :])
        K = torch.einsum("dn,dnl,dn->dl", Cc, P, dB).real
        L2 = 2 * L
        Kp = _pad(K, ((0, 0), (0, L)))
        up = (lambda x, *d: x.permute(*d))(u, 0, 2, 1)
        up = _pad(up, ((0, 0), (0, 0), (0, L)))
        Kf = (lambda x, axes=(-2,-1): torch.fft.rfft2(x.float(), dim=axes))(Kp[:, None, :], axes=(-2, -1))
        Uf = (lambda x, axes=(-2,-1): torch.fft.rfft2(x.float(), dim=axes))(up[:, :, None, :], axes=(-2, -1))
        Yf = Uf * Kf[None, :, :, :]
        y = (lambda x, s, axes=(-2,-1): torch.fft.irfft2(x, s=s, dim=axes).to(torch.bfloat16))(Yf, (1, L2), axes=(-2, -1))[:, :, 0, :L]
        y = (lambda x, *d: x.permute(*d))(y, 0, 2, 1) + u * Dskip[None, None, :]
        return y

    a = _A_ref(A_x, A_wqkv, A_wo)
    b = _B_ref(B_u, B_A_re, B_A_im, B_B_re, B_B_im, B_C_re, B_C_im, B_log_dt, B_Dskip)
    return torch.concatenate([a, b], axis=-1)
```

```asm
; @launch grid=(256,1,1) block=(512,1,1) lds=163840
.amdgcn_target "amdgcn-amd-amdhsa--gfx950"
.text
.p2align 12
.globl concat_heads__linear_attn_block__ssm_conv_s4__prompt_kernel
.p2align 8
.type concat_heads__linear_attn_block__ssm_conv_s4__prompt_kernel,@function
concat_heads__linear_attn_block__ssm_conv_s4__prompt_kernel:
  s_cmp_ge_u32 s2, 256
  s_cbranch_scc1 L_end
  s_load_dwordx16 s[8:23], s[0:1], 0
  s_load_dwordx8 s[24:31], s[0:1], 64
  s_load_dwordx4 s[32:35], s[0:1], 96
  s_load_dwordx2 s[36:37], s[0:1], 112
  s_getpc_b64 s[88:89]
  s_and_b32 s90, s2, 56
  s_lshl_b32 s90, s90, 4
  v_lshrrev_b32_e64 v6, 4, v0
  v_lshl_add_u32 v6, v6, 10, s90
  v_min_u32 v6, 30388, v6
  v_lshrrev_b32_e64 v1, 6, v0
  global_load_dword v7, v6, s[88:89]
  v_readfirstlane_b32 s3, v1
  v_and_b32 v2, 63, v0
  s_mov_b32 s101, 0
  s_cmp_ge_u32 s3, 4
  s_cbranch_scc1 L_helper
  s_lshl_b32 s91, s2, 10
  v_lshl_add_u32 v3, v0, 2, s91
  s_lshl_b32 s91, s2, 3
  v_lshl_add_u32 v5, v1, 1, s91
  s_lshr_b32 s90, s2, 2
  s_or_b32 s90, s90, s3
  s_waitcnt lgkmcnt(0)
  s_cbranch_scc1 L_par
  s_mul_i32 s90, s2, 2304
  s_add_u32 s90, s90, 524288
  v_min_u32 v8, 55, v2
  v_mul_u32_u24 v8, 8448, v8
  v_add_u32 v8, s90, v8
  v_mov_b32 v9, 0
  global_store_dword v8, v9, s[36:37] sc1
L_par:
  global_load_ushort v86, v5, s[28:29]
  global_load_dword v80, v3, s[16:17]
  global_load_dword v81, v3, s[18:19]
  global_load_dword v82, v3, s[20:21]
  global_load_dword v83, v3, s[22:23]
  global_load_dword v84, v3, s[24:25]
  global_load_dword v85, v3, s[26:27]
  global_load_ushort v87, v5, s[30:31]
  s_mov_b32 s101, 1
  s_cmp_eq_u32 s3, 1
  s_cbranch_scc1 L_pad_2
  s_cmp_eq_u32 s3, 2
  s_cbranch_scc1 L_pad_3
  s_cmp_eq_u32 s3, 3
  s_cbranch_scc1 L_pad_4
L_res_c:
  s_mov_b32 s101, 0
  s_branch L_compute
L_ev0:
  global_load_dword v5, v4, s[34:35] sc1
  s_branch L_evr0
L_ev2:
  s_mov_b32 s89, 200000
L_ev2l:
  v_cmp_le_u32_e64 vcc, 4, v5
  s_nop 0
  s_cbranch_vccnz L_ev2d
  global_load_dword v5, v4, s[34:35] sc1
  s_sub_u32 s89, s89, 1
  s_waitcnt vmcnt(0)
  s_cbranch_scc0 L_ev2l
L_ev2d:
  buffer_atomic_add v6, v7, s[48:51], s31 offen sc1
  s_branch L_evr2
L_helper:
  s_sub_u32 s64, s3, 4
  s_lshl_b32 s67, s64, 10
  v_lshrrev_b32 v3, 3, v2
  v_and_b32 v5, 3, v2
  v_lshlrev_b32 v5, 7, v5
  v_lshrrev_b32 v6, 2, v2
  v_lshl_add_u32 v13, v6, 11, v5
  v_lshl_add_u32 v12, v3, 26, v13
  s_lshr_b32 s88, s2, 3
  s_lshl2_add_u32 s88, s88, s64
  s_and_b32 s89, s2, 1
  s_bfe_u32 s95, s2, 0x20001
  s_mul_i32 s97, s88, 24
  s_add_u32 s97, s97, s95
  s_lshl_b32 s97, s97, 9
  s_lshl2_add_u32 s96, s89, s95
  s_lshl_b32 s96, s96, 7
  s_add_u32 s96, s96, s88
  s_lshl_b32 s96, s96, 12
  s_mul_i32 s89, s89, 12
  s_lshl_b32 s89, 0xfff, s89
  s_or_b32 vcc_lo, s89, 8947848
  s_mov_b32 vcc_hi, 0
  v_mov_b32 v5, 0x4000000
  v_cndmask_b32 v13, v5, v13, vcc
  s_waitcnt lgkmcnt(0)
  s_mov_b32 s40, s8
  s_mov_b32 s41, s9
  s_mov_b32 s42, 4194304
  s_mov_b32 s43, 0x20000
  s_mov_b32 s44, s10
  s_mov_b32 s45, s11
  s_mov_b32 s46, 6291456
  s_mov_b32 s47, 0x20000
  s_add_u32 s88, s96, 0
  buffer_load_dword v16, v12, s[40:43], s88 offen
  s_add_u32 s88, s97, 0
  buffer_load_dword v16, v13, s[44:47], s88 offen
  s_lshr_b32 s93, s2, 4
  s_and_b32 s94, s2, 15
  v_and_b32 v5, 3, v2
  v_lshlrev_b32 v5, 4, v5
  v_lshrrev_b32_e64 v6, 2, v2
  v_lshl_add_u32 v14, v6, 11, v5
  s_and_b32 s24, s2, 31
  s_lshr_b32 s88, s2, 5
  s_lshl2_add_u32 s25, s88, s64
  s_lshl_b32 s99, s24, 11
  s_add_u32 s99, s99, s25
  s_lshl_b32 s99, s99, 6
  s_mov_b32 s60, s14
  s_mov_b32 s61, s15
  s_mov_b32 s62, 4194304
  s_mov_b32 s63, 0x20000
  s_add_u32 m0, s67, 122880
  s_add_u32 s88, s99, 0
  buffer_load_dwordx4 v14, s[60:63], s88 offen lds
  s_add_u32 m0, s67, 126976
  s_add_u32 s88, s99, 32768
  buffer_load_dwordx4 v14, s[60:63], s88 offen lds
  s_add_u32 m0, s67, 131072
  s_add_u32 s88, s99, 65536
  buffer_load_dwordx4 v14, s[60:63], s88 offen lds
  s_add_u32 m0, s67, 135168
  s_add_u32 s88, s99, 98304
  buffer_load_dwordx4 v14, s[60:63], s88 offen lds
  s_mov_b32 s48, s36
  s_mov_b32 s49, s37
  s_mov_b32 s50, 20971520
  s_mov_b32 s51, 0x20000
  s_lshl2_add_u32 s90, s2, s64
  s_mul_i32 s91, s64, 8704
  s_waitcnt vmcnt(6)
  v_lshlrev_b32 v7, 26, v2
  v_and_b32_e64 v4, 1, v2
  v_mul_u32_u24 v4, 8192, v4
  v_bfe_u32 v5, v2, 2, 2
  v_lshl_add_u32 v4, v5, 6, v4
  v_and_b32 v5, 48, v2
  v_and_b32 v6, 2, v2
  v_lshl_add_u32 v5, v6, 2, v5
  s_add_u32 s88, s67, 122880
  v_add3_u32 v17, v4, v5, s88
  v_and_b32 v6, 7, v2
  v_lshlrev_b32 v5, 4, v6
  v_lshl_add_u32 v18, v3, 14, v5
  v_lshlrev_b32_e64 v11, 4, v2
  s_bfe_u32 s6, s2, 0x20001
  s_bfe_u32 s98, s2, 0x20003
  s_lshl2_add_u32 s6, s6, s98
  s_and_b32 s7, s2, 1
  s_lshr_b32 s98, s2, 5
  s_lshl3_add_u32 s7, s7, s98
  s_lshl_b32 s98, s7, 7
  s_mul_i32 s92, s64, 4608
  s_add_u32 s92, s92, 81920
  v_add_u32 v20, s91, v11
  v_lshl_add_u32 v19, v2, 3, s91
  v_min_u32_e64 v32, 1, v2
  v_lshl_add_u32 v32, v32, 2, v19
  v_add_u32 v32, 1024, v32
  v_mov_b32 v33, 1552
  v_add_u32 v33, s91, v33
  v_and_b32 v28, 15, v2
  v_lshrrev_b32 v29, 4, v2
  v_lshlrev_b32 v34, 2, v29
  v_sub_u32_e64 v34, v28, v34
  s_add_u32 s89, s91, 5108
  v_lshl_add_u32 v35, v34, 2, s89
  v_lshl_add_u32 v34, v28, 2, v35
  v_subrev_u32 v34, 444, v34
  v_and_b32 v21, 6, v3
  v_xor_b32 v21, v21, v2
  v_and_b32 v21, 7, v21
  v_lshlrev_b32 v21, 4, v21
  v_lshl_add_u32 v10, v3, 11, v21
  s_add_u32 s89, s91, 512
  v_lshlrev_b32 v23, 3, v2
  v_sub_u32 v21, s89, v23
  v_min_u32 v23, 19, v2
  v_lshrrev_b32 v24, 2, v23
  v_and_b32_e64 v25, 3, v23
  v_mul_u32_u24 v23, 1088, v24
  v_lshl_add_u32 v23, v25, 4, v23
  v_add_u32 v23, s91, v23
  v_lshlrev_b32 v36, 4, v24
  v_lshlrev_b64 v[36:37], v36, -1
  v_add_u32_e64 v25, 1, v25
  v_bfe_i32 v38, v25, 2, 1
  v_and_b32 v36, v36, v38
  v_and_b32 v37, v37, v38
  v_min_u32 v22, 1, v24
  v_min_u32 v24, 2, v24
  v_lshl_add_u32 v22, v22, 2, s91
  v_lshl_add_u32 v24, v24, 2, s91
  v_and_b32_e64 v15, 3, v2
  v_mul_u32_u24 v30, 1088, v15
  v_and_b32_e64 v15, 48, v2
  v_add3_u32 v30, v30, v15, s91
  v_lshl_add_u32 v31, v28, 5, v15
  v_add_u32 v31, s92, v31
  v_and_b32 v15, 12, v2
  v_lshlrev_b32 v15, 1, v15
  v_sub_u32 v15, 24, v15
  v_add_u32_e64 v30, v30, v15
  v_mov_b32 v26, 0x4000000
  v_mov_b32 v15, 34800
  v_lshl_add_u32 v27, v1, 2, v15
  v_mov_b32 v15, 1
  v_mov_b32 v25, 0
  v_lshlrev_b32_e64 v29, 3, v29
  v_mov_b32 v39, 4064
  v_lshlrev_b32 v39, v28, v39
  v_lshrrev_b32 v39, v29, v39
  v_bfe_u32 v88, v39, 0, 2
  v_bfe_u32 v89, v39, 2, 2
  v_bfe_u32 v90, v39, 4, 2
  v_bfe_u32 v91, v39, 6, 2
  v_mul_u32_u24 v88, 0x8001, v88
  v_mul_u32_u24 v89, 0x8001, v89
  v_mul_u32_u24 v90, 0x8001, v90
  v_mul_u32_u24 v91, 0x8001, v91
  v_and_b32 v88, 0x10001, v88
  v_and_b32 v89, 0x10001, v89
  v_and_b32 v90, 0x10001, v90
  v_and_b32 v91, 0x10001, v91
  v_mul_u32_u24 v88, 0x3f80, v88
  v_mul_u32_u24 v89, 0x3f80, v89
  v_mul_u32_u24 v90, 0x3f80, v90
  v_mul_u32_u24 v91, 0x3f80, v91
  v_mov_b32 v39, 8176
  v_lshlrev_b32 v39, v28, v39
  v_lshrrev_b32 v39, v29, v39
  v_bfe_u32 v92, v39, 0, 2
  v_bfe_u32 v93, v39, 2, 2
  v_bfe_u32 v94, v39, 4, 2
  v_bfe_u32 v95, v39, 6, 2
  v_mul_u32_u24 v92, 0x8001, v92
  v_mul_u32_u24 v93, 0x8001, v93
  v_mul_u32_u24 v94, 0x8001, v94
  v_mul_u32_u24 v95, 0x8001, v95
  v_and_b32 v92, 0x10001, v92
  v_and_b32 v93, 0x10001, v93
  v_and_b32 v94, 0x10001, v94
  v_and_b32 v95, 0x10001, v95
  v_mul_u32_u24 v92, 0x3f80, v92
  v_mul_u32_u24 v93, 0x3f80, v93
  v_mul_u32_u24 v94, 0x3f80, v94
  v_mul_u32_u24 v95, 0x3f80, v95
  v_mov_b32 v39, 14336
  v_lshlrev_b32 v39, v28, v39
  v_lshrrev_b32 v39, v29, v39
  v_bfe_u32 v152, v39, 0, 2
  v_bfe_u32 v153, v39, 2, 2
  v_bfe_u32 v154, v39, 4, 2
  v_bfe_u32 v155, v39, 6, 2
  v_mul_u32_u24 v152, 0x8001, v152
  v_mul_u32_u24 v153, 0x8001, v153
  v_mul_u32_u24 v154, 0x8001, v154
  v_mul_u32_u24 v155, 0x8001, v155
  v_and_b32 v152, 0x10001, v152
  v_and_b32 v153, 0x10001, v153
  v_and_b32 v154, 0x10001, v154
  v_and_b32 v155, 0x10001, v155
  v_mul_u32_u24 v152, 0x3f80, v152
  v_mul_u32_u24 v153, 0x3f80, v153
  v_mul_u32_u24 v154, 0x3f80, v154
  v_mul_u32_u24 v155, 0x3f80, v155
  v_mov_b32 v39, 1984
  v_lshlrev_b32 v39, v28, v39
  v_lshrrev_b32 v39, v29, v39
  v_bfe_u32 v156, v39, 0, 2
  v_bfe_u32 v157, v39, 2, 2
  v_bfe_u32 v158, v39, 4, 2
  v_bfe_u32 v159, v39, 6, 2
  v_mul_u32_u24 v156, 0x8001, v156
  v_mul_u32_u24 v157, 0x8001, v157
  v_mul_u32_u24 v158, 0x8001, v158
  v_mul_u32_u24 v159, 0x8001, v159
  v_and_b32 v156, 0x10001, v156
  v_and_b32 v157, 0x10001, v157
  v_and_b32 v158, 0x10001, v158
  v_and_b32 v159, 0x10001, v159
  v_mul_u32_u24 v156, 0x3f80, v156
  v_mul_u32_u24 v157, 0x3f80, v157
  v_mul_u32_u24 v158, 0x3f80, v158
  v_mul_u32_u24 v159, 0x3f80, v159
  v_mov_b32 v39, 12288
  v_lshlrev_b32 v39, v28, v39
  v_lshrrev_b32 v39, v29, v39
  v_bfe_u32 v148, v39, 0, 2
  v_bfe_u32 v149, v39, 2, 2
  v_bfe_u32 v150, v39, 4, 2
  v_bfe_u32 v151, v39, 6, 2
  v_mul_u32_u24 v148, 0x8001, v148
  v_mul_u32_u24 v149, 0x8001, v149
  v_mul_u32_u24 v150, 0x8001, v150
  v_mul_u32_u24 v151, 0x8001, v151
  v_and_b32 v148, 0x10001, v148
  v_and_b32 v149, 0x10001, v149
  v_and_b32 v150, 0x10001, v150
  v_and_b32 v151, 0x10001, v151
  v_mul_u32_u24 v148, 0xffff, v148
  v_mul_u32_u24 v149, 0xffff, v149
  v_mul_u32_u24 v150, 0xffff, v150
  v_mul_u32_u24 v151, 0xffff, v151
  s_and_b32 s4, s2, 1
  s_bfe_u32 s88, s2, 0x30003
  s_lshl3_add_u32 s4, s4, s88
  s_bfe_u32 s5, s2, 0x20001
  s_lshr_b32 s88, s2, 6
  s_lshl2_add_u32 s5, s5, s88
  v_bfe_u32 v4, v0, 3, 5
  v_lshrrev_b32 v5, 1, v4
  v_xor_b32 v6, v5, v2
  v_and_b32 v6, 7, v6
  v_lshlrev_b32 v6, 4, v6
  v_lshl_add_u32 v8, v4, 11, v6
  v_and_b32_e64 v5, 4, v5
  v_and_or_b32 v5, v4, 2, v5
  v_xor_b32 v5, v5, v2
  v_and_b32 v5, 7, v5
  v_mul_u32_u24 v6, 6144, v4
  v_lshl_add_u32 v9, v5, 4, v6
  s_lshl_b32 s65, s4, 18
  s_lshl_b32 s66, s5, 7
  s_add_u32 m0, s67, 40960
  s_add_u32 s88, s65, 0
  buffer_load_dwordx4 v8, s[40:43], s88 offen  lds
  s_add_u32 m0, s67, 45056
  s_add_u32 s88, s65, 65536
  buffer_load_dwordx4 v8, s[40:43], s88 offen  lds
  s_add_u32 m0, s67, 49152
  s_add_u32 s88, s65, 131072
  buffer_load_dwordx4 v8, s[40:43], s88 offen  lds
  s_add_u32 m0, s67, 53248
  s_add_u32 s88, s65, 196608
  buffer_load_dwordx4 v8, s[40:43], s88 offen  lds
  s_add_u32 m0, s67, 57344
  s_add_u32 s88, s66, 0
  buffer_load_dwordx4 v9, s[44:47], s88 offen  lds
  s_add_u32 m0, s67, 61440
  s_add_u32 s88, s66, 196608
  buffer_load_dwordx4 v9, s[44:47], s88 offen  lds
  s_add_u32 m0, s67, 65536
  s_add_u32 s88, s66, 2048
  buffer_load_dwordx4 v9, s[44:47], s88 offen  lds
  s_add_u32 m0, s67, 69632
  s_add_u32 s88, s66, 198656
  buffer_load_dwordx4 v9, s[44:47], s88 offen  lds
  s_add_u32 m0, s67, 73728
  s_add_u32 s88, s66, 4096
  buffer_load_dwordx4 v9, s[44:47], s88 offen  lds
  s_add_u32 m0, s67, 77824
  s_add_u32 s88, s66, 200704
  buffer_load_dwordx4 v9, s[44:47], s88 offen  lds
  s_add_u32 s88, s96, 512
  buffer_load_dword v16, v12, s[40:43], s88 offen
  s_add_u32 s88, s97, 1572864
  buffer_load_dword v16, v13, s[44:47], s88 offen
  s_setprio 1
  s_waitcnt vmcnt(12)
  ds_read_b64_tr_b16 v[240:241], v17 offset:0
  ds_read_b64_tr_b16 v[242:243], v17 offset:256
  ds_read_b64_tr_b16 v[244:245], v17 offset:512
  ds_read_b64_tr_b16 v[246:247], v17 offset:768
  ds_read_b64_tr_b16 v[248:249], v17 offset:4096
  ds_read_b64_tr_b16 v[250:251], v17 offset:4352
  ds_read_b64_tr_b16 v[252:253], v17 offset:4608
  ds_read_b64_tr_b16 v[254:255], v17 offset:4864
  s_lshl_b32 s99, s25, 10
  s_add_u32 s99, s99, s24
  s_lshl_b32 s99, s99, 7
  s_mov_b32 vcc_lo, 0x55555555
  s_mov_b32 vcc_hi, 0x55555555
  s_waitcnt lgkmcnt(5)
  v_cndmask_b32_dpp v224, v244, v240, vcc quad_perm:[1,0,3,2] row_mask:0xf bank_mask:0xf
  v_cndmask_b32_dpp v225, v245, v241, vcc quad_perm:[1,0,3,2] row_mask:0xf bank_mask:0xf
  s_waitcnt lgkmcnt(4)
  v_cndmask_b32_dpp v226, v246, v242, vcc quad_perm:[1,0,3,2] row_mask:0xf bank_mask:0xf
  v_cndmask_b32_dpp v227, v247, v243, vcc quad_perm:[1,0,3,2] row_mask:0xf bank_mask:0xf
  s_waitcnt lgkmcnt(1)
  v_cndmask_b32_dpp v232, v252, v248, vcc quad_perm:[1,0,3,2] row_mask:0xf bank_mask:0xf
  v_cndmask_b32_dpp v233, v253, v249, vcc quad_perm:[1,0,3,2] row_mask:0xf bank_mask:0xf
  s_waitcnt lgkmcnt(0)
  v_cndmask_b32_dpp v234, v254, v250, vcc quad_perm:[1,0,3,2] row_mask:0xf bank_mask:0xf
  v_cndmask_b32_dpp v235, v255, v251, vcc quad_perm:[1,0,3,2] row_mask:0xf bank_mask:0xf
  s_not_b64 vcc, vcc
  v_cndmask_b32_dpp v228, v240, v244, vcc quad_perm:[1,0,3,2] row_mask:0xf bank_mask:0xf
  v_cndmask_b32_dpp v229, v241, v245, vcc quad_perm:[1,0,3,2] row_mask:0xf bank_mask:0xf
  v_cndmask_b32_dpp v230, v242, v246, vcc quad_perm:[1,0,3,2] row_mask:0xf bank_mask:0xf
  v_cndmask_b32_dpp v231, v243, v247, vcc quad_perm:[1,0,3,2] row_mask:0xf bank_mask:0xf
  v_cndmask_b32_dpp v236, v248, v252, vcc quad_perm:[1,0,3,2] row_mask:0xf bank_mask:0xf
  v_cndmask_b32_dpp v237, v249, v253, vcc quad_perm:[1,0,3,2] row_mask:0xf bank_mask:0xf
  v_cndmask_b32_dpp v238, v250, v254, vcc quad_perm:[1,0,3,2] row_mask:0xf bank_mask:0xf
  v_cndmask_b32_dpp v239, v251, v255, vcc quad_perm:[1,0,3,2] row_mask:0xf bank_mask:0xf
  s_mov_b32 vcc_lo, 0x33333333
  s_mov_b32 vcc_hi, 0x33333333
  v_cndmask_b32_dpp v240, v232, v224, vcc quad_perm:[2,3,0,1] row_mask:0xf bank_mask:0xf
  v_cndmask_b32_dpp v241, v233, v225, vcc quad_perm:[2,3,0,1] row_mask:0xf bank_mask:0xf
  v_cndmask_b32_dpp v242, v234, v226, vcc quad_perm:[2,3,0,1] row_mask:0xf bank_mask:0xf
  v_cndmask_b32_dpp v243, v235, v227, vcc quad_perm:[2,3,0,1] row_mask:0xf bank_mask:0xf
  v_cndmask_b32_dpp v244, v236, v228, vcc quad_perm:[2,3,0,1] row_mask:0xf bank_mask:0xf
  v_cndmask_b32_dpp v245, v237, v229, vcc quad_perm:[2,3,0,1] row_mask:0xf bank_mask:0xf
  v_cndmask_b32_dpp v246, v238, v230, vcc quad_perm:[2,3,0,1] row_mask:0xf bank_mask:0xf
  v_cndmask_b32_dpp v247, v239, v231, vcc quad_perm:[2,3,0,1] row_mask:0xf bank_mask:0xf
  s_not_b64 vcc, vcc
  v_cndmask_b32_dpp v248, v224, v232, vcc quad_perm:[2,3,0,1] row_mask:0xf bank_mask:0xf
  v_cndmask_b32_dpp v249, v225, v233, vcc quad_perm:[2,3,0,1] row_mask:0xf bank_mask:0xf
  v_cndmask_b32_dpp v250, v226, v234, vcc quad_perm:[2,3,0,1] row_mask:0xf bank_mask:0xf
  v_cndmask_b32_dpp v251, v227, v235, vcc quad_perm:[2,3,0,1] row_mask:0xf bank_mask:0xf
  v_cndmask_b32_dpp v252, v228, v236, vcc quad_perm:[2,3,0,1] row_mask:0xf bank_mask:0xf
  v_cndmask_b32_dpp v253, v229, v237, vcc quad_perm:[2,3,0,1] row_mask:0xf bank_mask:0xf
  v_cndmask_b32_dpp v254, v230, v238, vcc quad_perm:[2,3,0,1] row_mask:0xf bank_mask:0xf
  v_cndmask_b32_dpp v255, v231, v239, vcc quad_perm:[2,3,0,1] row_mask:0xf bank_mask:0xf
  s_add_u32 s95, s99, 4194304
  buffer_store_dwordx4 v[240:243], v18, s[48:51], s95 offen sc1
  s_add_u32 s95, s99, 4198400
  buffer_store_dwordx4 v[244:247], v18, s[48:51], s95 offen sc1
  s_add_u32 s95, s99, 4202496
  buffer_store_dwordx4 v[248:251], v18, s[48:51], s95 offen sc1
  s_add_u32 s95, s99, 4206592
  buffer_store_dwordx4 v[252:255], v18, s[48:51], s95 offen sc1
  s_mov_b32 s101, 1
  s_cmp_eq_u32 s64, 0
  s_cbranch_scc1 L_pad_0
  s_cmp_eq_u32 s64, 1
  s_cbranch_scc1 L_pad_1
  s_cmp_eq_u32 s64, 2
  s_cbranch_scc1 L_pad_5
  s_cmp_eq_u32 s64, 3
  s_cbranch_scc1 L_pad_6
L_res_h:
  s_mov_b32 s101, 0
  s_add_u32 s18, s8, s96
  s_addc_u32 s19, s9, 0
  s_lshr_b32 s88, s2, 3
  s_and_b32 s89, s2, 1
  s_lshl1_add_u32 s88, s88, s89
  s_add_u32 s88, s88, 512
  s_mul_i32 s88, s88, 12
  s_bfe_u32 s89, s2, 0x20001
  s_add_u32 s88, s88, s89
  s_lshl2_add_u32 s88, s88, s64
  s_lshl_b32 s88, s88, 7
  s_add_u32 s20, s10, s88
  s_addc_u32 s21, s11, 0
  s_lshr_b32 s88, s2, 3
  s_andn2_b32 s95, 1, s2
  s_lshl1_add_u32 s88, s88, s95
  s_add_u32 s88, s88, 512
  s_mul_i32 s88, s88, 12
  s_add_u32 s88, s88, s89
  s_min_u32 s95, s64, 2
  s_lshl2_add_u32 s88, s95, s88
  s_lshl_b32 s88, s88, 9
  s_add_u32 s26, s10, s88
  s_addc_u32 s27, s11, 0
  s_lshl2_add_u32 s88, s2, s64
  s_lshl_b32 s88, s88, 7
  s_add_u32 s22, s12, s88
  s_addc_u32 s23, s13, 0
  s_mov_b32 s52, s32
  s_mov_b32 s53, s33
  s_mov_b32 s54, 8388608
  s_mov_b32 s55, 0x20000
  s_mov_b32 s56, s12
  s_mov_b32 s57, s13
  s_mov_b32 s58, 2097152
  s_mov_b32 s59, 0x20000
  s_lshr_b32 s31, s2, 5
  s_mul_i32 s31, s31, 8448
  s_add_u32 s31, s31, 929792
  s_mov_b32 s30, 0
  s_cmp_eq_u32 s64, 0
  s_cselect_b32 s28, 1, 9
  v_mov_b32 v4, 0
  v_mov_b32_e64 v6, 1
  s_setprio 0
  s_load_dwordx2 s[16:17], s[22:23], 60
  s_load_dwordx2 s[16:17], s[22:23], 131132
  s_load_dwordx2 s[16:17], s[22:23], 262204
  s_load_dwordx2 s[16:17], s[22:23], 393276
  s_add_u32 s22, s22, 524288
  s_addc_u32 s23, s23, 0
  s_add_u32 m0, s67, 81920
  s_add_u32 s88, s65, 128
  buffer_load_dwordx4 v8, s[40:43], s88 offen  lds
  s_add_u32 m0, s67, 86016
  s_add_u32 s88, s65, 65664
  buffer_load_dwordx4 v8, s[40:43], s88 offen  lds
  s_add_u32 m0, s67, 90112
  s_add_u32 s88, s65, 131200
  buffer_load_dwordx4 v8, s[40:43], s88 offen  lds
  s_add_u32 m0, s67, 94208
  s_add_u32 s88, s65, 196736
  buffer_load_dwordx4 v8, s[40:43], s88 offen  lds
  s_add_u32 m0, s67, 98304
  s_add_u32 s88, s66, 393216
  buffer_load_dwordx4 v9, s[44:47], s88 offen  lds
  s_add_u32 m0, s67, 102400
  s_add_u32 s88, s66, 589824
  buffer_load_dwordx4 v9, s[44:47], s88 offen  lds
  s_add_u32 m0, s67, 106496
  s_add_u32 s88, s66, 395264
  buffer_load_dwordx4 v9, s[44:47], s88 offen  lds
  s_add_u32 m0, s67, 110592
  s_add_u32 s88, s66, 591872
  buffer_load_dwordx4 v9, s[44:47], s88 offen  lds
  s_add_u32 m0, s67, 114688
  s_add_u32 s88, s66, 397312
L_pad_0:
  s_cmp_eq_u32 s101, 1
  s_cbranch_scc1 L_res_h
  buffer_load_dwordx4 v9, s[44:47], s88 offen  lds
  s_add_u32 m0, s67, 118784
  s_add_u32 s88, s66, 593920
  buffer_load_dwordx4 v9, s[44:47], s88 offen  lds
  s_waitcnt vmcnt(16)
  s_barrier
  s_add_u32 m0, s67, 122880
  s_add_u32 s88, s65, 256
  buffer_load_dwordx4 v8, s[40:43], s88 offen  lds
  s_add_u32 m0, s67, 126976
  s_add_u32 s88, s65, 65792
  buffer_load_dwordx4 v8, s[40:43], s88 offen  lds
.p2align 3
L_hloop:
  s_add_u32 m0, s67, 131072
  s_add_u32 s88, s65, 131328
  buffer_load_dwordx4 v8, s[40:43], s88 offen  lds
  s_load_dwordx2 s[16:17], s[20:21], 60
  s_add_u32 m0, s67, 135168
  s_add_u32 s88, s65, 196864
  buffer_load_dwordx4 v8, s[40:43], s88 offen  lds
  s_add_u32 m0, s67, 139264
  s_add_u32 s88, s66, 786432
  buffer_load_dwordx4 v9, s[44:47], s88 offen  lds
  s_load_dwordx2 s[16:17], s[20:21], 2108
  s_add_u32 m0, s67, 143360
  s_add_u32 s88, s66, 983040
  buffer_load_dwordx4 v9, s[44:47], s88 offen  lds
  s_cmp_eq_u32 s30, s28
  s_cbranch_scc1 L_ev0
L_evr0:
  s_add_u32 m0, s67, 147456
  s_add_u32 s88, s66, 788480
  buffer_load_dwordx4 v9, s[44:47], s88 offen  lds
  s_load_dwordx2 s[16:17], s[20:21], 4156
  s_add_u32 m0, s67, 151552
  s_add_u32 s88, s66, 985088
  buffer_load_dwordx4 v9, s[44:47], s88 offen  lds
  s_add_u32 m0, s67, 155648
  s_add_u32 s88, s66, 790528
  buffer_load_dwordx4 v9, s[44:47], s88 offen  lds
  s_load_dwordx2 s[16:17], s[18:19], 1084
  s_add_u32 m0, s67, 159744
  s_add_u32 s88, s66, 987136
  buffer_load_dwordx4 v9, s[44:47], s88 offen  lds
  s_add_u32 m0, s67, 40960
  s_add_u32 s88, s65, 384
  s_waitcnt vmcnt(10)
  s_barrier
  buffer_load_dwordx4 v8, s[40:43], s88 offen  lds
  s_load_dwordx2 s[16:17], s[18:19], 3132
  s_add_u32 m0, s67, 45056
  s_add_u32 s88, s65, 65920
  buffer_load_dwordx4 v8, s[40:43], s88 offen  lds
  s_add_u32 m0, s67, 49152
  s_add_u32 s88, s65, 131456
  buffer_load_dwordx4 v8, s[40:43], s88 offen  lds
  s_add_u32 m0, s67, 53248
  s_add_u32 s88, s65, 196992
  buffer_load_dwordx4 v8, s[40:43], s88 offen  lds
  s_load_dwordx2 s[16:17], s[26:27], -392772
  s_add_u32 m0, s67, 57344
  s_add_u32 s88, s66, 1179648
  buffer_load_dwordx4 v9, s[44:47], s88 offen  lds
  s_add_u32 m0, s67, 61440
  s_add_u32 s88, s66, 1376256
  buffer_load_dwordx4 v9, s[44:47], s88 offen  lds
  s_load_dwordx2 s[16:17], s[20:21], 393276
  s_add_u32 m0, s67, 65536
  s_add_u32 s88, s66, 1181696
  buffer_load_dwordx4 v9, s[44:47], s88 offen  lds
  s_add_u32 m0, s67, 69632
  s_add_u32 s88, s66, 1378304
  buffer_load_dwordx4 v9, s[44:47], s88 offen  lds
  s_add_u32 m0, s67, 73728
  s_add_u32 s88, s66, 1183744
  buffer_load_dwordx4 v9, s[44:47], s88 offen  lds
  s_load_dwordx2 s[16:17], s[20:21], 395324
  s_add_u32 m0, s67, 77824
  s_add_u32 s88, s66, 1380352
  buffer_load_dwordx4 v9, s[44:47], s88 offen  lds
  s_add_u32 m0, s67, 81920
  s_add_u32 s88, s65, 512
  s_waitcnt vmcnt(10)
  s_barrier
  buffer_load_dwordx4 v8, s[40:43], s88 offen  lds
  s_load_dwordx2 s[16:17], s[20:21], 397372
  s_add_u32 m0, s67, 86016
  s_add_u32 s88, s65, 66048
  buffer_load_dwordx4 v8, s[40:43], s88 offen  lds
  s_add_u32 s20, s20, 786432
  s_addc_u32 s21, s21, 0
  s_add_u32 m0, s67, 90112
  s_add_u32 s88, s65, 131584
  buffer_load_dwordx4 v8, s[40:43], s88 offen  lds
  s_load_dwordx2 s[16:17], s[18:19], 1212
  s_add_u32 m0, s67, 94208
  s_add_u32 s88, s65, 197120
  buffer_load_dwordx4 v8, s[40:43], s88 offen  lds
  s_add_u32 s65, s65, 384
  s_add_u32 m0, s67, 98304
  s_add_u32 s88, s66, 1572864
  buffer_load_dwordx4 v9, s[44:47], s88 offen  lds
  s_load_dwordx2 s[16:17], s[18:19], 3260
  s_add_u32 s18, s18, 256
  s_addc_u32 s19, s19, 0
  s_add_u32 m0, s67, 102400
  s_add_u32 s88, s66, 1769472
  buffer_load_dwordx4 v9, s[44:47], s88 offen  lds
  s_cmp_eq_u32 s30, s28
  s_cbranch_scc1 L_ev2
L_evr2:
  s_add_u32 m0, s67, 106496
  s_add_u32 s88, s66, 1574912
  buffer_load_dwordx4 v9, s[44:47], s88 offen  lds
  s_load_dwordx2 s[16:17], s[26:27], 444
  s_add_u32 m0, s67, 110592
  s_add_u32 s88, s66, 1771520
  buffer_load_dwordx4 v9, s[44:47], s88 offen  lds
  s_load_dwordx2 s[16:17], s[22:23], 60
  s_add_u32 s26, s26, 786432
  s_addc_u32 s27, s27, 0
  s_add_u32 m0, s67, 114688
  s_add_u32 s88, s66, 1576960
  buffer_load_dwordx4 v9, s[44:47], s88 offen  lds
  s_add_u32 s22, s22, 131072
  s_addc_u32 s23, s23, 0
  s_add_u32 s30, s30, 1
  s_add_u32 m0, s67, 118784
  s_add_u32 s88, s66, 1773568
  s_add_u32 s66, s66, 1179648
  buffer_load_dwordx4 v9, s[44:47], s88 offen  lds
  s_add_u32 m0, s67, 122880
  s_add_u32 s88, s65, 256
  s_waitcnt vmcnt(10)
  s_barrier
  buffer_load_dwordx4 v8, s[40:43], s88 offen  lds
  s_add_u32 m0, s67, 126976
  s_add_u32 s88, s65, 65792
  s_cmp_lt_u32 s30, 4
  buffer_load_dwordx4 v8, s[40:43], s88 offen  lds
  s_cbranch_scc1 L_hloop
  s_cmp_lg_u32 s64, 0
  s_cbranch_scc1 L_ev_1
  buffer_load_dword v5, v7, s[48:51], s31 offen sc1
L_ev_1:
  s_load_dwordx2 s[16:17], s[26:27], -392772
  s_add_u32 m0, s67, 131072
  s_add_u32 s88, s65, 131328
  buffer_load_dwordx4 v8, s[40:43], s88 offen  lds
  s_add_u32 m0, s67, 135168
  s_add_u32 s88, s65, 196864
  buffer_load_dwordx4 v8, s[40:43], s88 offen  lds
  s_load_dwordx2 s[16:17], s[22:23], 524348
  s_add_u32 m0, s67, 139264
  s_add_u32 s88, s66, 786432
  buffer_load_dwordx4 v9, s[44:47], s88 offen  lds
  s_add_u32 m0, s67, 143360
  s_add_u32 s88, s66, 983040
  buffer_load_dwordx4 v9, s[44:47], s88 offen  lds
  s_load_dwordx2 s[16:17], s[22:23], 655420
  s_add_u32 m0, s67, 147456
  s_add_u32 s88, s66, 788480
  buffer_load_dwordx4 v9, s[44:47], s88 offen  lds
  s_add_u32 m0, s67, 151552
  s_add_u32 s88, s66, 985088
  buffer_load_dwordx4 v9, s[44:47], s88 offen  lds
  s_load_dwordx2 s[16:17], s[22:23], 786492
  s_add_u32 m0, s67, 155648
  s_add_u32 s88, s66, 790528
  buffer_load_dwordx4 v9, s[44:47], s88 offen  lds
  s_add_u32 m0, s67, 159744
  s_add_u32 s88, s66, 987136
  buffer_load_dwordx4 v9, s[44:47], s88 offen  lds
  s_load_dwordx2 s[16:17], s[22:23], 917564
  s_waitcnt vmcnt(10)
  s_barrier
  s_add_u32 m0, s67, 40960
  s_add_u32 s88, s65, 384
  buffer_load_dwordx4 v8, s[40:43], s88 offen  lds
  s_add_u32 m0, s67, 45056
  s_add_u32 s88, s65, 65920
  buffer_load_dwordx4 v8, s[40:43], s88 offen  lds
  s_load_dwordx2 s[16:17], s[22:23], 60
  s_add_u32 m0, s67, 49152
  s_add_u32 s88, s65, 131456
  buffer_load_dwordx4 v8, s[40:43], s88 offen  lds
  s_add_u32 m0, s67, 53248
  s_add_u32 s88, s65, 196992
  buffer_load_dwordx4 v8, s[40:43], s88 offen  lds
  s_load_dwordx2 s[16:17], s[22:23], 131132
  s_add_u32 m0, s67, 57344
  s_add_u32 s88, s66, 1179648
  buffer_load_dwordx4 v9, s[44:47], s88 offen  lds
  s_add_u32 m0, s67, 61440
  s_add_u32 s88, s66, 1376256
  buffer_load_dwordx4 v9, s[44:47], s88 offen  lds
  s_load_dwordx2 s[16:17], s[22:23], 262204
  s_add_u32 m0, s67, 65536
  s_add_u32 s88, s66, 1181696
  buffer_load_dwordx4 v9, s[44:47], s88 offen  lds
  s_add_u32 m0, s67, 69632
  s_add_u32 s88, s66, 1378304
  buffer_load_dwordx4 v9, s[44:47], s88 offen  lds
  s_load_dwordx2 s[16:17], s[22:23], 393276
  s_add_u32 m0, s67, 73728
  s_add_u32 s88, s66, 1183744
  buffer_load_dwordx4 v9, s[44:47], s88 offen  lds
  s_add_u32 m0, s67, 77824
  s_add_u32 s88, s66, 1380352
  buffer_load_dwordx4 v9, s[44:47], s88 offen  lds
  s_waitcnt vmcnt(10)
  s_cmp_lg_u32 s64, 0
  s_cbranch_scc1 L_ev_2
  s_mov_b32 s89, 200000
L_evs_3:
  v_readfirstlane_b32 s88, v5
  s_nop 0
  s_cmp_ge_u32 s88, 32
  s_cbranch_scc1 L_ev_2
  v_mov_b32_e64 v5, 0
  buffer_atomic_add v5, v7, s[48:51], s31 offen sc0 sc1
  s_sub_u32 s89, s89, 1
  s_waitcnt vmcnt(0)
  s_cbranch_scc0 L_evs_3
L_ev_2:
  s_barrier
  s_lshl_b32 s89, s90, 12
  s_add_u32 s89, s89, 4194304
  s_mov_b32 m0, s92
  s_nop 0
  buffer_load_dwordx4 v26, s[48:51], 0 offen lds
  s_add_u32 m0, s92, 480
  s_lshl_b32 s96, s64, 16
  s_xor_b32 s96, s96, s98
  s_lshl_b32 s97, s64, 14
  s_add_u32 s97, s97, s98
  v_mov_b32 v14, 34816
  buffer_load_dwordx4 v11, s[48:51], s89 offen offset:0 sc1 lds
  buffer_load_dwordx4 v11, s[48:51], s89 offen offset:1024 sc1 lds
  buffer_load_dwordx4 v11, s[48:51], s89 offen offset:2048 sc1 lds
  buffer_load_dwordx4 v11, s[48:51], s89 offen offset:3072 sc1 lds
  s_add_u32 m0, s67, 102400
  s_xor_b32 s88, s97, 0
  buffer_load_dwordx4 v10, s[56:59], s88 offen  lds
  s_add_u32 m0, s67, 106496
  s_xor_b32 s88, s97, 65536
  buffer_load_dwordx4 v10, s[56:59], s88 offen  lds
  s_add_u32 m0, s67, 110592
  s_xor_b32 s88, s97, 131072
  buffer_load_dwordx4 v10, s[56:59], s88 offen  lds
  s_add_u32 m0, s67, 114688
  s_xor_b32 s88, s97, 196608
  buffer_load_dwordx4 v10, s[56:59], s88 offen  lds
  s_waitcnt vmcnt(9)
  s_barrier
  s_add_u32 m0, s67, 122880
  s_xor_b32 s88, s97, 262144
  buffer_load_dwordx4 v10, s[56:59], s88 offen  lds
  s_add_u32 m0, s67, 126976
  s_xor_b32 s88, s97, 327680
  buffer_load_dwordx4 v10, s[56:59], s88 offen  lds
  s_add_u32 m0, s67, 131072
  s_xor_b32 s88, s97, 393216
  buffer_load_dwordx4 v10, s[56:59], s88 offen  lds
  s_add_u32 m0, s67, 135168
  s_xor_b32 s88, s97, 458752
  buffer_load_dwordx4 v10, s[56:59], s88 offen  lds
  s_add_u32 m0, s67, 139264
  s_xor_b32 s88, s97, 524288
  buffer_load_dwordx4 v10, s[56:59], s88 offen  lds
  s_add_u32 m0, s67, 143360
  s_xor_b32 s88, s97, 589824
  buffer_load_dwordx4 v10, s[56:59], s88 offen  lds
  s_add_u32 m0, s67, 147456
  s_xor_b32 s88, s97, 655360
  buffer_load_dwordx4 v10, s[56:59], s88 offen  lds
  s_add_u32 m0, s67, 151552
  s_xor_b32 s88, s97, 720896
  buffer_load_dwordx4 v10, s[56:59], s88 offen  lds
  s_add_u32 m0, s67, 155648
  s_xor_b32 s88, s97, 786432
  buffer_load_dwordx4 v10, s[56:59], s88 offen  lds
  s_add_u32 m0, s67, 159744
  s_xor_b32 s88, s97, 851968
  buffer_load_dwordx4 v10, s[56:59], s88 offen  lds
  s_xor_b32 s88, s96, 1572864
  buffer_load_dwordx4 v[40:43], v10, s[56:59], s88 offen
  ds_read_b128 v[164:167], v20 offset:0
  ds_read_b128 v[168:171], v20 offset:16
  ds_read2_b32 v[172:173], v32 offset0:1 offset1:2
  s_xor_b32 s88, s96, 1589248
  buffer_load_dwordx4 v[44:47], v10, s[56:59], s88 offen
  ds_read_b32 v174, v32 offset:12
  ds_read_b64 v[176:177], v19 offset:1040
  ds_read_b32 v178, v19 offset:1048
  s_xor_b32 s88, s96, 1605632
  buffer_load_dwordx4 v[48:51], v10, s[56:59], s88 offen
  ds_read2_b32 v[180:181], v33 offset0:0 offset1:128
  ds_read_b32 v182, v22 offset:1548
  ds_read_b32 v183, v24 offset:1544
  s_xor_b32 s88, s96, 1622016
  buffer_load_dwordx4 v[52:55], v10, s[56:59], s88 offen
  s_xor_b32 s88, s96, 1835008
  buffer_load_dwordx4 v[56:59], v10, s[56:59], s88 offen
  s_xor_b32 s88, s96, 1851392
  buffer_load_dwordx4 v[60:63], v10, s[56:59], s88 offen
  s_xor_b32 s88, s96, 1867776
  buffer_load_dwordx4 v[64:67], v10, s[56:59], s88 offen
  s_xor_b32 s88, s96, 1884160
  buffer_load_dwordx4 v[68:71], v10, s[56:59], s88 offen
  v_cmp_eq_u32 vcc, 0, v2
  v_lshlrev_b32 v12, 4, v28
  v_sub_u32 v12, v31, v12
  v_mov_b32 v212, 0
  s_waitcnt lgkmcnt(0)
  v_cndmask_b32 v165, v165, v25, vcc
  v_cndmask_b32 v166, v166, v25, vcc
  v_cndmask_b32 v167, v167, v25, vcc
  v_cvt_pk_bf16_f32 v196, v168, v167
  v_cvt_pk_bf16_f32 v197, v166, v165
  ds_write_b64 v21, v[196:197] offset:568
  v_cvt_pk_bf16_f32 v200, v169, v168
  v_cvt_pk_bf16_f32 v201, v167, v166
  ds_write_b64 v21, v[200:201] offset:1656
  v_cvt_pk_bf16_f32 v204, v170, v169
  v_cvt_pk_bf16_f32 v205, v168, v167
  ds_write_b64 v21, v[204:205] offset:2744
  v_cvt_pk_bf16_f32 v208, v171, v170
  v_cvt_pk_bf16_f32 v209, v169, v168
  ds_write_b64 v21, v[208:209] offset:3832
  v_cvt_pk_bf16_f32 v198, v176, v174
  v_cvt_pk_bf16_f32 v199, v173, v172
  ds_write_b64 v21, v[198:199] offset:56
  v_cvt_pk_bf16_f32 v202, v176, v176
  v_cvt_pk_bf16_f32 v203, v174, v173
  ds_write_b64 v21, v[202:203] offset:1144
  v_cvt_pk_bf16_f32 v206, v177, v176
  v_cvt_pk_bf16_f32 v207, v176, v174
  ds_write_b64 v21, v[206:207] offset:2232
  v_cvt_pk_bf16_f32 v210, v178, v177
  v_cvt_pk_bf16_f32 v211, v176, v176
  ds_write_b64 v21, v[210:211] offset:3320
  v_cvt_pk_bf16_f32 v214, v180, v180
  v_cvt_pk_bf16_f32 v215, v182, v183
  v_cvt_pk_bf16_f32 v180, v181, v181
  v_and_b32 v213, v214, v36
  v_and_b32 v214, v214, v37
  v_and_b32_e64 v215, v215, v38
  ds_write_b128 v23, v[212:215]
  v_and_b32 v148, v148, v180
  v_and_b32 v149, v149, v180
  v_and_b32 v150, v150, v180
  v_and_b32 v151, v151, v180
  s_waitcnt vmcnt(8)
  s_mov_b64 exec, 1
  ds_add_u32 v14, v15 offset:128
  s_mov_b64 exec, -1
  ds_read_b64 v[128:129], v30 offset:1024
  ds_read_b64 v[130:131], v30 offset:1032
  ds_read_b128 v[164:167], v31 offset:448
  ds_read_b128 v[228:231], v31 offset:432
  ds_read_b128 v[168:171], v31 offset:960
  ds_read_b64 v[132:133], v30 offset:512
  ds_read_b64 v[134:135], v30 offset:520
  ds_read_b128 v[232:235], v31 offset:944
  ds_read_b128 v[172:175], v31 offset:1472
  ds_read_b64 v[144:145], v30 offset:0
  ds_read_b64 v[146:147], v30 offset:8
  ds_read_b128 v[236:239], v31 offset:1456
  ds_read_b128 v[176:179], v31 offset:1984
  ds_read_b128 v[240:243], v31 offset:1968
  ds_read_b128 v[180:183], v31 offset:2496
  ds_read_b128 v[184:187], v31 offset:3008
  ds_read_b128 v[188:191], v31 offset:3520
  ds_read_b128 v[192:195], v31 offset:4032
  v_and_b32 v4, 3, v2
  v_lshl_add_u32 v4, v4, 2, v14
L_lpoll_4:
  ds_read_b32 v5, v4 offset:0
  s_waitcnt lgkmcnt(0)
  v_cmp_ne_u32 vcc, 1, v5
  s_nop 0
  s_cbranch_vccnz L_lpoll_4
  v_mfma_f32_16x16x32_bf16 v[244:247], v[164:167], v[88:91], 0
  ds_read_b64 v[136:137], v30 offset:960
  v_mfma_f32_16x16x32_bf16 v[248:251], v[228:231], v[92:95], 0
  ds_read_b64 v[138:139], v30 offset:968
  v_mfma_f32_16x16x32_bf16 v[96:99], v[128:131], v[164:167], 0
  ds_read_b128 v[196:199], v31 offset:384
  v_mfma_f32_16x16x32_bf16 v[100:103], v[128:131], v[168:171], 0
  s_add_u32 m0, s67, 40960
  s_xor_b32 s88, s97, 917504
  buffer_load_dwordx4 v10, s[56:59], s88 offen  lds
  v_mfma_f32_16x16x32_bf16 v[100:103], v[132:135], v[164:167], v[100:103]
  ds_read_b128 v[200:203], v31 offset:896
  v_mfma_f32_16x16x32_bf16 v[104:107], v[128:131], v[172:175], 0
  v_cvt_pk_bf16_f32 v228, v244, v248
  v_cvt_pk_bf16_f32 v229, v245, v249
  v_mfma_f32_16x16x32_bf16 v[104:107], v[132:135], v[168:171], v[104:107]
  v_cvt_pk_bf16_f32 v230, v246, v250
  v_cvt_pk_bf16_f32 v231, v247, v251
  v_mfma_f32_16x16x32_bf16 v[104:107], v[144:147], v[164:167], v[104:107]
  ds_read_b64 v[140:141], v30 offset:448
  v_mfma_f32_16x16x32_bf16 v[244:247], v[168:171], v[88:91], 0
  ds_read_b64 v[142:143], v30 offset:456
  v_mfma_f32_16x16x32_bf16 v[248:251], v[232:235], v[92:95], 0
  ds_read_b128 v[204:207], v31 offset:1408
  v_mfma_f32_16x16x32_bf16 v[108:111], v[128:131], v[176:179], 0
  ds_read_b128 v[208:211], v31 offset:1920
  v_mfma_f32_16x16x32_bf16 v[108:111], v[132:135], v[172:175], v[108:111]
  ds_read_b128 v[212:215], v31 offset:2432
  v_mfma_f32_16x16x32_bf16 v[108:111], v[144:147], v[168:171], v[108:111]
  s_add_u32 m0, s67, 45056
  s_xor_b32 s88, s97, 983040
  buffer_load_dwordx4 v10, s[56:59], s88 offen  lds
  v_mfma_f32_16x16x32_bf16 v[112:115], v[128:131], v[180:183], 0
  v_cvt_pk_bf16_f32 v232, v244, v248
  v_cvt_pk_bf16_f32 v233, v245, v249
  v_mfma_f32_16x16x32_bf16 v[112:115], v[132:135], v[176:179], v[112:115]
  v_cvt_pk_bf16_f32 v234, v246, v250
  v_cvt_pk_bf16_f32 v235, v247, v251
  v_mfma_f32_16x16x32_bf16 v[112:115], v[144:147], v[172:175], v[112:115]
  ds_read_b128 v[216:219], v31 offset:2944
  v_mfma_f32_16x16x32_bf16 v[244:247], v[172:175], v[88:91], 0
  ds_read_b128 v[220:223], v31 offset:3456
  v_mfma_f32_16x16x32_bf16 v[248:251], v[236:239], v[92:95], 0
  ds_read_b128 v[224:227], v31 offset:3968
  v_mfma_f32_16x16x32_bf16 v[112:115], v[148:151], v[164:167], v[112:115]
  ds_read2_b32 v[72:73], v35 offset0:3 offset1:2
  v_mfma_f32_16x16x32_bf16 v[116:119], v[128:131], v[184:187], 0
  ds_read2_b32 v[74:75], v35 offset0:1 offset1:0
  v_mfma_f32_16x16x32_bf16 v[116:119], v[132:135], v[180:183], v[116:119]
  ds_read2_b32 v[76:77], v35 offset0:19 offset1:18
  v_mfma_f32_16x16x32_bf16 v[116:119], v[144:147], v[176:179], v[116:119]
  v_cvt_pk_bf16_f32 v236, v244, v248
  v_cvt_pk_bf16_f32 v237, v245, v249
  v_mfma_f32_16x16x32_bf16 v[116:119], v[148:151], v[168:171], v[116:119]
  v_cvt_pk_bf16_f32 v238, v246, v250
  v_cvt_pk_bf16_f32 v239, v247, v251
  v_mfma_f32_16x16x32_bf16 v[120:123], v[128:131], v[188:191], 0
  s_add_u32 m0, s67, 49152
  s_xor_b32 s88, s97, 1048576
  buffer_load_dwordx4 v10, s[56:59], s88 offen  lds
  v_mfma_f32_16x16x32_bf16 v[244:247], v[176:179], v[88:91], 0
  ds_read2_b32 v[78:79], v35 offset0:17 offset1:16
  v_mfma_f32_16x16x32_bf16 v[248:251], v[240:243], v[92:95], 0
  ds_read2_b32 v[80:81], v35 offset0:35 offset1:34
  v_mfma_f32_16x16x32_bf16 v[120:123], v[132:135], v[184:187], v[120:123]
  ds_read2_b32 v[82:83], v35 offset0:33 offset1:32
  v_mfma_f32_16x16x32_bf16 v[120:123], v[144:147], v[180:183], v[120:123]
  ds_read2_b32 v[84:85], v35 offset0:51 offset1:50
  v_mfma_f32_16x16x32_bf16 v[120:123], v[148:151], v[172:175], v[120:123]
  ds_read2_b32 v[86:87], v35 offset0:49 offset1:48
  v_mfma_f32_16x16x32_bf16 v[124:127], v[128:131], v[192:195], 0
  v_cvt_pk_bf16_f32 v240, v244, v248
  v_cvt_pk_bf16_f32 v241, v245, v249
  v_mfma_f32_16x16x32_bf16 v[124:127], v[132:135], v[188:191], v[124:127]
  v_cvt_pk_bf16_f32 v242, v246, v250
  v_cvt_pk_bf16_f32 v243, v247, v251
  v_mfma_f32_16x16x32_bf16 v[124:127], v[144:147], v[184:187], v[124:127]
  v_mfma_f32_16x16x32_bf16 v[124:127], v[148:151], v[176:179], v[124:127]
  s_waitcnt lgkmcnt(6)
  v_mfma_f32_16x16x32_bf16 v[112:115], v[228:231], v[72:75], v[112:115]
  ds_read_b64 v[128:129], v30 offset:896
  v_mfma_f32_16x16x32_bf16 v[116:119], v[232:235], v[72:75], v[116:119]
  ds_read_b64 v[130:131], v30 offset:904
  s_waitcnt lgkmcnt(6)
  v_mfma_f32_16x16x32_bf16 v[116:119], v[228:231], v[76:79], v[116:119]
  ds_read_b128 v[164:167], v31 offset:320
  v_mfma_f32_16x16x32_bf16 v[120:123], v[236:239], v[72:75], v[120:123]
  s_add_u32 m0, s67, 53248
  s_xor_b32 s88, s97, 1114112
  buffer_load_dwordx4 v10, s[56:59], s88 offen  lds
  v_mfma_f32_16x16x32_bf16 v[120:123], v[232:235], v[76:79], v[120:123]
  ds_read_b128 v[168:171], v31 offset:832
  s_waitcnt lgkmcnt(6)
  v_mfma_f32_16x16x32_bf16 v[120:123], v[228:231], v[80:83], v[120:123]
  ds_read_b64 v[132:133], v30 offset:384
  v_mfma_f32_16x16x32_bf16 v[124:127], v[240:243], v[72:75], v[124:127]
  ds_read_b64 v[134:135], v30 offset:392
  v_mfma_f32_16x16x32_bf16 v[124:127], v[236:239], v[76:79], v[124:127]
  ds_read_b128 v[172:175], v31 offset:1344
  v_mfma_f32_16x16x32_bf16 v[124:127], v[232:235], v[80:83], v[124:127]
  s_add_u32 m0, s67, 57344
  s_xor_b32 s88, s97, 1179648
  buffer_load_dwordx4 v10, s[56:59], s88 offen  lds
  s_waitcnt lgkmcnt(7)
  v_mfma_f32_16x16x32_bf16 v[124:127], v[228:231], v[84:87], v[124:127]
  ds_read_b128 v[176:179], v31 offset:1856
  v_mfma_f32_16x16x32_bf16 v[96:99], v[136:139], v[196:199], v[96:99]
  ds_read_b128 v[180:183], v31 offset:2368
  v_mfma_f32_16x16x32_bf16 v[100:103], v[136:139], v[200:203], v[100:103]
  ds_read_b128 v[184:187], v31 offset:2880
  v_mfma_f32_16x16x32_bf16 v[100:103], v[140:143], v[196:199], v[100:103]
  ds_read_b128 v[188:191], v31 offset:3392
  v_mfma_f32_16x16x32_bf16 v[104:107], v[136:139], v[204:207], v[104:107]
  s_add_u32 m0, s67, 61440
  s_xor_b32 s88, s97, 1245184
  buffer_load_dwordx4 v10, s[56:59], s88 offen  lds
  v_mfma_f32_16x16x32_bf16 v[104:107], v[140:143], v[200:203], v[104:107]
  ds_read_b128 v[192:195], v31 offset:3904
  v_mfma_f32_16x16x32_bf16 v[108:111], v[136:139], v[208:211], v[108:111]
  v_mfma_f32_16x16x32_bf16 v[108:111], v[140:143], v[204:207], v[108:111]
  v_mfma_f32_16x16x32_bf16 v[112:115], v[136:139], v[212:215], v[112:115]
  ds_read_b128 v[228:231], v12 offset:3248
  v_mfma_f32_16x16x32_bf16 v[112:115], v[140:143], v[208:211], v[112:115]
  v_mfma_f32_16x16x32_bf16 v[116:119], v[136:139], v[216:219], v[116:119]
  v_mfma_f32_16x16x32_bf16 v[116:119], v[140:143], v[212:215], v[116:119]
  v_mfma_f32_16x16x32_bf16 v[120:123], v[136:139], v[220:223], v[120:123]
  v_mfma_f32_16x16x32_bf16 v[120:123], v[140:143], v[216:219], v[120:123]
  v_mfma_f32_16x16x32_bf16 v[124:127], v[136:139], v[224:227], v[124:127]
  v_mfma_f32_16x16x32_bf16 v[124:127], v[140:143], v[220:223], v[124:127]
  s_waitcnt lgkmcnt(0)
  v_mfma_f32_16x16x32_bf16 v[244:247], v[228:231], v[152:155], 0
  ds_read_b128 v[232:235], v12 offset:2992
  v_mfma_f32_16x16x32_bf16 v[248:251], v[228:231], v[156:159], 0
  ds_read2_b32 v[72:73], v34 offset0:3 offset1:2
  v_mfma_f32_16x16x32_bf16 v[96:99], v[128:131], v[164:167], v[96:99]
  ds_read2_b32 v[74:75], v34 offset0:1 offset1:0
  v_mfma_f32_16x16x32_bf16 v[100:103], v[128:131], v[168:171], v[100:103]
  ds_read_b64 v[136:137], v30 offset:832
  v_mfma_f32_16x16x32_bf16 v[100:103], v[132:135], v[164:167], v[100:103]
  s_nop 1
  v_cvt_pk_bf16_f32 v228, v244, v248
  v_cvt_pk_bf16_f32 v229, v245, v249
  ds_read_b64 v[138:139], v30 offset:840
  v_mfma_f32_16x16x32_bf16 v[104:107], v[128:131], v[172:175], v[104:107]
  v_cvt_pk_bf16_f32 v230, v246, v250
  v_cvt_pk_bf16_f32 v231, v247, v251
  ds_read_b128 v[196:199], v31 offset:256
  v_mfma_f32_16x16x32_bf16 v[104:107], v[132:135], v[168:171], v[104:107]
  s_add_u32 m0, s67, 65536
  s_xor_b32 s88, s97, 1310720
  buffer_load_dwordx4 v10, s[56:59], s88 offen  lds
  v_mfma_f32_16x16x32_bf16 v[108:111], v[128:131], v[176:179], v[108:111]
  ds_read_b128 v[200:203], v31 offset:768
  s_waitcnt lgkmcnt(6)
  v_mfma_f32_16x16x32_bf16 v[244:247], v[232:235], v[152:155], 0
  ds_read_b128 v[236:239], v12 offset:2736
  v_mfma_f32_16x16x32_bf16 v[248:251], v[232:235], v[156:159], 0
  ds_read2_b32 v[76:77], v34 offset0:19 offset1:18
  s_waitcnt lgkmcnt(6)
  v_mfma_f32_16x16x32_bf16 v[124:127], v[228:231], v[72:75], v[124:127]
  ds_read_b64 v[140:141], v30 offset:320
  v_mfma_f32_16x16x32_bf16 v[108:111], v[132:135], v[172:175], v[108:111]
  ds_read2_b32 v[78:79], v34 offset0:17 offset1:16
  v_mfma_f32_16x16x32_bf16 v[112:115], v[128:131], v[180:183], v[112:115]
  ds_read_b64 v[142:143], v30 offset:328
  v_mfma_f32_16x16x32_bf16 v[112:115], v[132:135], v[176:179], v[112:115]
  v_cvt_pk_bf16_f32 v232, v244, v248
  v_cvt_pk_bf16_f32 v233, v245, v249
  ds_read_b128 v[204:207], v31 offset:1280
  v_mfma_f32_16x16x32_bf16 v[116:119], v[128:131], v[184:187], v[116:119]
  v_cvt_pk_bf16_f32 v234, v246, v250
L_pad_1:
  s_cmp_eq_u32 s101, 1
  s_cbranch_scc1 L_res_h
  v_cvt_pk_bf16_f32 v235, v247, v251
  s_add_u32 m0, s67, 69632
  s_xor_b32 s88, s97, 1376256
  buffer_load_dwordx4 v10, s[56:59], s88 offen  lds
  v_mfma_f32_16x16x32_bf16 v[116:119], v[132:135], v[180:183], v[116:119]
  ds_read_b128 v[208:211], v31 offset:1792
  v_mfma_f32_16x16x32_bf16 v[120:123], v[128:131], v[188:191], v[120:123]
  ds_read_b128 v[212:215], v31 offset:2304
  s_waitcnt lgkmcnt(7)
  v_mfma_f32_16x16x32_bf16 v[244:247], v[236:239], v[152:155], 0
  ds_read_b128 v[240:243], v12 offset:2480
  v_mfma_f32_16x16x32_bf16 v[248:251], v[236:239], v[156:159], 0
  ds_read2_b32 v[80:81], v34 offset0:35 offset1:34
  s_waitcnt lgkmcnt(6)
  v_mfma_f32_16x16x32_bf16 v[124:127], v[232:235], v[76:79], v[124:127]
  ds_read_b128 v[216:219], v31 offset:2816
  v_mfma_f32_16x16x32_bf16 v[120:123], v[132:135], v[184:187], v[120:123]
  ds_read2_b32 v[82:83], v34 offset0:33 offset1:32
  v_mfma_f32_16x16x32_bf16 v[124:127], v[128:131], v[192:195], v[124:127]
  ds_read_b128 v[220:223], v31 offset:3328
  v_mfma_f32_16x16x32_bf16 v[124:127], v[132:135], v[188:191], v[124:127]
  v_cvt_pk_bf16_f32 v236, v244, v248
  v_cvt_pk_bf16_f32 v237, v245, v249
  s_add_u32 m0, s67, 73728
  s_xor_b32 s88, s97, 1441792
  buffer_load_dwordx4 v10, s[56:59], s88 offen  lds
  ds_read_b128 v[224:227], v31 offset:3840
  v_mfma_f32_16x16x32_bf16 v[96:99], v[136:139], v[196:199], v[96:99]
  v_cvt_pk_bf16_f32 v238, v246, v250
  v_cvt_pk_bf16_f32 v239, v247, v251
  ds_read_b64 v[128:129], v30 offset:768
  v_mfma_f32_16x16x32_bf16 v[100:103], v[136:139], v[200:203], v[100:103]
  ds_read_b64 v[130:131], v30 offset:776
  s_waitcnt lgkmcnt(11)
  v_mfma_f32_16x16x32_bf16 v[100:103], v[140:143], v[196:199], v[100:103]
  ds_read_b128 v[164:167], v31 offset:192
  s_waitcnt lgkmcnt(8)
  v_mfma_f32_16x16x32_bf16 v[244:247], v[240:243], v[152:155], 0
  ds_read_b128 v[228:231], v12 offset:2224
  v_mfma_f32_16x16x32_bf16 v[248:251], v[240:243], v[156:159], 0
  ds_read2_b32 v[84:85], v34 offset0:51 offset1:50
  v_mfma_f32_16x16x32_bf16 v[120:123], v[236:239], v[72:75], v[120:123]
  s_add_u32 m0, s67, 77824
  s_xor_b32 s88, s97, 1507328
  buffer_load_dwordx4 v10, s[56:59], s88 offen  lds
  s_waitcnt lgkmcnt(7)
  v_mfma_f32_16x16x32_bf16 v[124:127], v[236:239], v[80:83], v[124:127]
  ds_read_b128 v[168:171], v31 offset:704
  v_mfma_f32_16x16x32_bf16 v[104:107], v[136:139], v[204:207], v[104:107]
  ds_read2_b32 v[86:87], v34 offset0:49 offset1:48
  v_mfma_f32_16x16x32_bf16 v[104:107], v[140:143], v[200:203], v[104:107]
  ds_read_b64 v[132:133], v30 offset:256
  v_mfma_f32_16x16x32_bf16 v[108:111], v[136:139], v[208:211], v[108:111]
  v_cvt_pk_bf16_f32 v240, v244, v248
  v_cvt_pk_bf16_f32 v241, v245, v249
  v_mfma_f32_16x16x32_bf16 v[108:111], v[140:143], v[204:207], v[108:111]
  v_cvt_pk_bf16_f32 v242, v246, v250
  v_cvt_pk_bf16_f32 v243, v247, v251
  v_mfma_f32_16x16x32_bf16 v[112:115], v[136:139], v[212:215], v[112:115]
  ds_read_b64 v[134:135], v30 offset:264
  v_mfma_f32_16x16x32_bf16 v[112:115], v[140:143], v[208:211], v[112:115]
  ds_read_b128 v[172:175], v31 offset:1216
  s_waitcnt lgkmcnt(6)
  v_mfma_f32_16x16x32_bf16 v[244:247], v[228:231], v[152:155], 0
  ds_read_b128 v[232:235], v12 offset:1968
  v_mfma_f32_16x16x32_bf16 v[248:251], v[228:231], v[156:159], 0
  ds_read2_b32 v[88:89], v34 offset0:67 offset1:66
  v_mfma_f32_16x16x32_bf16 v[120:123], v[240:243], v[76:79], v[120:123]
  ds_read_b128 v[176:179], v31 offset:1728
  s_waitcnt lgkmcnt(6)
  v_mfma_f32_16x16x32_bf16 v[124:127], v[240:243], v[84:87], v[124:127]
  ds_read_b128 v[180:183], v31 offset:2240
  v_mfma_f32_16x16x32_bf16 v[116:119], v[136:139], v[216:219], v[116:119]
  ds_read2_b32 v[90:91], v34 offset0:65 offset1:64
  v_mfma_f32_16x16x32_bf16 v[116:119], v[140:143], v[212:215], v[116:119]
  ds_read_b128 v[184:187], v31 offset:2752
  v_mfma_f32_16x16x32_bf16 v[120:123], v[136:139], v[220:223], v[120:123]
  v_cvt_pk_bf16_f32 v228, v244, v248
  v_cvt_pk_bf16_f32 v229, v245, v249
  v_mfma_f32_16x16x32_bf16 v[120:123], v[140:143], v[216:219], v[120:123]
  v_cvt_pk_bf16_f32 v230, v246, v250
  v_cvt_pk_bf16_f32 v231, v247, v251
  v_mfma_f32_16x16x32_bf16 v[124:127], v[136:139], v[224:227], v[124:127]
  ds_read_b128 v[188:191], v31 offset:3264
  v_mfma_f32_16x16x32_bf16 v[124:127], v[140:143], v[220:223], v[124:127]
  ds_read_b128 v[192:195], v31 offset:3776
  s_waitcnt lgkmcnt(7)
  v_mfma_f32_16x16x32_bf16 v[244:247], v[232:235], v[152:155], 0
  ds_read_b128 v[236:239], v12 offset:1712
  v_mfma_f32_16x16x32_bf16 v[248:251], v[232:235], v[156:159], 0
  ds_read2_b32 v[92:93], v34 offset0:83 offset1:82
  v_mfma_f32_16x16x32_bf16 v[116:119], v[228:231], v[72:75], v[116:119]
  ds_read_b64 v[136:137], v30 offset:704
  v_mfma_f32_16x16x32_bf16 v[120:123], v[228:231], v[80:83], v[120:123]
  ds_read_b64 v[138:139], v30 offset:712
  s_waitcnt lgkmcnt(7)
  v_mfma_f32_16x16x32_bf16 v[124:127], v[228:231], v[88:91], v[124:127]
  ds_read_b128 v[196:199], v31 offset:128
  v_mfma_f32_16x16x32_bf16 v[96:99], v[128:131], v[164:167], v[96:99]
  ds_read2_b32 v[94:95], v34 offset0:81 offset1:80
  v_mfma_f32_16x16x32_bf16 v[100:103], v[128:131], v[168:171], v[100:103]
  ds_read_b128 v[200:203], v31 offset:640
  v_mfma_f32_16x16x32_bf16 v[100:103], v[132:135], v[164:167], v[100:103]
  v_cvt_pk_bf16_f32 v232, v244, v248
  v_cvt_pk_bf16_f32 v233, v245, v249
  v_mfma_f32_16x16x32_bf16 v[104:107], v[128:131], v[172:175], v[104:107]
  v_cvt_pk_bf16_f32 v234, v246, v250
  v_cvt_pk_bf16_f32 v235, v247, v251
  v_mfma_f32_16x16x32_bf16 v[104:107], v[132:135], v[168:171], v[104:107]
  ds_read_b64 v[140:141], v30 offset:192
  v_mfma_f32_16x16x32_bf16 v[108:111], v[128:131], v[176:179], v[108:111]
  ds_read_b64 v[142:143], v30 offset:200
  s_waitcnt lgkmcnt(8)
  v_mfma_f32_16x16x32_bf16 v[244:247], v[236:239], v[152:155], 0
  ds_read_b128 v[240:243], v12 offset:1456
  v_mfma_f32_16x16x32_bf16 v[248:251], v[236:239], v[156:159], 0
  ds_read_b128 v[204:207], v31 offset:1152
  v_mfma_f32_16x16x32_bf16 v[116:119], v[232:235], v[76:79], v[116:119]
  ds_read_b128 v[208:211], v31 offset:1664
  v_mfma_f32_16x16x32_bf16 v[120:123], v[232:235], v[84:87], v[120:123]
  ds_read_b128 v[212:215], v31 offset:2176
  s_waitcnt lgkmcnt(7)
  v_mfma_f32_16x16x32_bf16 v[124:127], v[232:235], v[92:95], v[124:127]
  ds_read_b128 v[216:219], v31 offset:2688
  v_mfma_f32_16x16x32_bf16 v[108:111], v[132:135], v[172:175], v[108:111]
  ds_read_b128 v[220:223], v31 offset:3200
  v_mfma_f32_16x16x32_bf16 v[112:115], v[128:131], v[180:183], v[112:115]
  ds_read_b128 v[224:227], v31 offset:3712
  v_mfma_f32_16x16x32_bf16 v[112:115], v[132:135], v[176:179], v[112:115]
  v_cvt_pk_bf16_f32 v236, v244, v248
  v_cvt_pk_bf16_f32 v237, v245, v249
  v_mfma_f32_16x16x32_bf16 v[116:119], v[128:131], v[184:187], v[116:119]
  v_cvt_pk_bf16_f32 v238, v246, v250
  v_cvt_pk_bf16_f32 v239, v247, v251
  v_mfma_f32_16x16x32_bf16 v[116:119], v[132:135], v[180:183], v[116:119]
  v_mfma_f32_16x16x32_bf16 v[120:123], v[128:131], v[188:191], v[120:123]
  s_waitcnt lgkmcnt(6)
  v_mfma_f32_16x16x32_bf16 v[244:247], v[240:243], v[152:155], 0
  ds_read_b128 v[228:231], v12 offset:1200
  v_mfma_f32_16x16x32_bf16 v[248:251], v[240:243], v[156:159], 0
  v_mfma_f32_16x16x32_bf16 v[112:115], v[236:239], v[72:75], v[112:115]
  v_mfma_f32_16x16x32_bf16 v[116:119], v[236:239], v[80:83], v[116:119]
  v_mfma_f32_16x16x32_bf16 v[120:123], v[236:239], v[88:91], v[120:123]
  v_mfma_f32_16x16x32_bf16 v[120:123], v[132:135], v[184:187], v[120:123]
  v_mfma_f32_16x16x32_bf16 v[124:127], v[128:131], v[192:195], v[124:127]
  v_mfma_f32_16x16x32_bf16 v[124:127], v[132:135], v[188:191], v[124:127]
  s_nop 1
  v_cvt_pk_bf16_f32 v240, v244, v248
  v_cvt_pk_bf16_f32 v241, v245, v249
  v_mfma_f32_16x16x32_bf16 v[96:99], v[136:139], v[196:199], v[96:99]
  v_cvt_pk_bf16_f32 v242, v246, v250
  v_cvt_pk_bf16_f32 v243, v247, v251
  v_mfma_f32_16x16x32_bf16 v[100:103], v[136:139], v[200:203], v[100:103]
  ds_read_b64 v[128:129], v30 offset:640
  v_mfma_f32_16x16x32_bf16 v[100:103], v[140:143], v[196:199], v[100:103]
  ds_read_b64 v[130:131], v30 offset:648
  s_waitcnt lgkmcnt(2)
  v_mfma_f32_16x16x32_bf16 v[244:247], v[228:231], v[152:155], 0
  ds_read_b128 v[232:235], v12 offset:944
  v_mfma_f32_16x16x32_bf16 v[248:251], v[228:231], v[156:159], 0
  ds_read_b128 v[164:167], v31 offset:64
  v_mfma_f32_16x16x32_bf16 v[112:115], v[240:243], v[76:79], v[112:115]
  ds_read_b128 v[168:171], v31 offset:576
  v_mfma_f32_16x16x32_bf16 v[116:119], v[240:243], v[84:87], v[116:119]
  ds_read_b64 v[132:133], v30 offset:128
  v_mfma_f32_16x16x32_bf16 v[120:123], v[240:243], v[92:95], v[120:123]
  ds_read_b64 v[134:135], v30 offset:136
  v_mfma_f32_16x16x32_bf16 v[104:107], v[136:139], v[204:207], v[104:107]
  ds_read_b128 v[172:175], v31 offset:1088
  v_mfma_f32_16x16x32_bf16 v[104:107], v[140:143], v[200:203], v[104:107]
  ds_read_b128 v[176:179], v31 offset:1600
  v_mfma_f32_16x16x32_bf16 v[108:111], v[136:139], v[208:211], v[108:111]
  v_cvt_pk_bf16_f32 v228, v244, v248
  v_cvt_pk_bf16_f32 v229, v245, v249
  v_mfma_f32_16x16x32_bf16 v[108:111], v[140:143], v[204:207], v[108:111]
  v_cvt_pk_bf16_f32 v230, v246, v250
  v_cvt_pk_bf16_f32 v231, v247, v251
  v_mfma_f32_16x16x32_bf16 v[112:115], v[136:139], v[212:215], v[112:115]
  ds_read_b128 v[180:183], v31 offset:2112
  v_mfma_f32_16x16x32_bf16 v[112:115], v[140:143], v[208:211], v[112:115]
  ds_read_b128 v[184:187], v31 offset:2624
  s_waitcnt lgkmcnt(8)
  v_mfma_f32_16x16x32_bf16 v[244:247], v[232:235], v[152:155], 0
  ds_read_b128 v[236:239], v12 offset:688
  v_mfma_f32_16x16x32_bf16 v[248:251], v[232:235], v[156:159], 0
  ds_read_b128 v[188:191], v31 offset:3136
  v_mfma_f32_16x16x32_bf16 v[108:111], v[228:231], v[72:75], v[108:111]
  ds_read_b128 v[192:195], v31 offset:3648
  v_mfma_f32_16x16x32_bf16 v[112:115], v[228:231], v[80:83], v[112:115]
  v_mfma_f32_16x16x32_bf16 v[116:119], v[228:231], v[88:91], v[116:119]
  v_mfma_f32_16x16x32_bf16 v[116:119], v[136:139], v[216:219], v[116:119]
  v_mfma_f32_16x16x32_bf16 v[116:119], v[140:143], v[212:215], v[116:119]
  v_mfma_f32_16x16x32_bf16 v[120:123], v[136:139], v[220:223], v[120:123]
  v_cvt_pk_bf16_f32 v232, v244, v248
  v_cvt_pk_bf16_f32 v233, v245, v249
  v_mfma_f32_16x16x32_bf16 v[120:123], v[140:143], v[216:219], v[120:123]
  v_cvt_pk_bf16_f32 v234, v246, v250
  v_cvt_pk_bf16_f32 v235, v247, v251
  v_mfma_f32_16x16x32_bf16 v[124:127], v[136:139], v[224:227], v[124:127]
  v_mfma_f32_16x16x32_bf16 v[124:127], v[140:143], v[220:223], v[124:127]
  s_waitcnt lgkmcnt(2)
  v_mfma_f32_16x16x32_bf16 v[244:247], v[236:239], v[152:155], 0
  ds_read_b128 v[240:243], v12 offset:432
  v_mfma_f32_16x16x32_bf16 v[248:251], v[236:239], v[156:159], 0
  ds_read_b64 v[136:137], v30 offset:576
  v_mfma_f32_16x16x32_bf16 v[108:111], v[232:235], v[76:79], v[108:111]
  ds_read_b64 v[138:139], v30 offset:584
  v_mfma_f32_16x16x32_bf16 v[112:115], v[232:235], v[84:87], v[112:115]
  ds_read_b128 v[196:199], v31 offset:0
  v_mfma_f32_16x16x32_bf16 v[116:119], v[232:235], v[92:95], v[116:119]
  ds_read_b128 v[200:203], v31 offset:512
  v_mfma_f32_16x16x32_bf16 v[96:99], v[128:131], v[164:167], v[96:99]
  ds_read_b64 v[140:141], v30 offset:64
  v_mfma_f32_16x16x32_bf16 v[100:103], v[128:131], v[168:171], v[100:103]
  ds_read_b64 v[142:143], v30 offset:72
  v_mfma_f32_16x16x32_bf16 v[100:103], v[132:135], v[164:167], v[100:103]
  v_cvt_pk_bf16_f32 v236, v244, v248
  v_cvt_pk_bf16_f32 v237, v245, v249
  v_mfma_f32_16x16x32_bf16 v[104:107], v[128:131], v[172:175], v[104:107]
  v_cvt_pk_bf16_f32 v238, v246, v250
  v_cvt_pk_bf16_f32 v239, v247, v251
  v_mfma_f32_16x16x32_bf16 v[104:107], v[132:135], v[168:171], v[104:107]
  ds_read_b128 v[204:207], v31 offset:1024
  v_mfma_f32_16x16x32_bf16 v[108:111], v[128:131], v[176:179], v[108:111]
  ds_read_b128 v[208:211], v31 offset:1536
  s_waitcnt lgkmcnt(8)
  v_mfma_f32_16x16x32_bf16 v[244:247], v[240:243], v[152:155], 0
  ds_read_b128 v[212:215], v31 offset:2048
  v_mfma_f32_16x16x32_bf16 v[248:251], v[240:243], v[156:159], 0
  ds_read_b128 v[216:219], v31 offset:2560
  v_mfma_f32_16x16x32_bf16 v[104:107], v[236:239], v[72:75], v[104:107]
  ds_read_b128 v[220:223], v31 offset:3072
  v_mfma_f32_16x16x32_bf16 v[108:111], v[236:239], v[80:83], v[108:111]
  ds_read_b128 v[224:227], v31 offset:3584
  v_mfma_f32_16x16x32_bf16 v[112:115], v[236:239], v[88:91], v[112:115]
  v_mfma_f32_16x16x32_bf16 v[108:111], v[132:135], v[172:175], v[108:111]
  v_mfma_f32_16x16x32_bf16 v[112:115], v[128:131], v[180:183], v[112:115]
  v_mfma_f32_16x16x32_bf16 v[112:115], v[132:135], v[176:179], v[112:115]
  v_cvt_pk_bf16_f32 v240, v244, v248
  v_cvt_pk_bf16_f32 v241, v245, v249
  v_mfma_f32_16x16x32_bf16 v[116:119], v[128:131], v[184:187], v[116:119]
  v_cvt_pk_bf16_f32 v242, v246, v250
  v_cvt_pk_bf16_f32 v243, v247, v251
  v_mfma_f32_16x16x32_bf16 v[116:119], v[132:135], v[180:183], v[116:119]
  v_mfma_f32_16x16x32_bf16 v[120:123], v[128:131], v[188:191], v[120:123]
  v_mfma_f32_16x16x32_bf16 v[104:107], v[240:243], v[76:79], v[104:107]
  v_mfma_f32_16x16x32_bf16 v[108:111], v[240:243], v[84:87], v[108:111]
  v_mfma_f32_16x16x32_bf16 v[112:115], v[240:243], v[92:95], v[112:115]
  v_mfma_f32_16x16x32_bf16 v[120:123], v[132:135], v[184:187], v[120:123]
  v_mfma_f32_16x16x32_bf16 v[124:127], v[128:131], v[192:195], v[124:127]
  v_mfma_f32_16x16x32_bf16 v[124:127], v[132:135], v[188:191], v[124:127]
  s_waitcnt lgkmcnt(9)
  v_mfma_f32_16x16x32_bf16 v[96:99], v[136:139], v[196:199], v[96:99]
  s_waitcnt vmcnt(0)
  s_mov_b64 exec, 1
  ds_add_u32 v14, v15 offset:48
  s_mov_b64 exec, -1
  s_waitcnt lgkmcnt(9)
  v_mfma_f32_16x16x32_bf16 v[100:103], v[136:139], v[200:203], v[100:103]
  s_lshl_b32 s89, s90, 12
  s_add_u32 s89, s89, 8388608
  s_waitcnt lgkmcnt(7)
  v_mfma_f32_16x16x32_bf16 v[100:103], v[140:143], v[196:199], v[100:103]
  s_waitcnt lgkmcnt(6)
  v_mfma_f32_16x16x32_bf16 v[104:107], v[136:139], v[204:207], v[104:107]
  v_mfma_f32_16x16x32_bf16 v[104:107], v[140:143], v[200:203], v[104:107]
  s_waitcnt lgkmcnt(5)
  v_mfma_f32_16x16x32_bf16 v[108:111], v[136:139], v[208:211], v[108:111]
  v_mfma_f32_16x16x32_bf16 v[108:111], v[140:143], v[204:207], v[108:111]
  s_waitcnt lgkmcnt(4)
  v_mfma_f32_16x16x32_bf16 v[112:115], v[136:139], v[212:215], v[112:115]
  v_cvt_pk_bf16_f32 v164, v96, v97
  v_cvt_pk_bf16_f32 v165, v98, v99
  v_mfma_f32_16x16x32_bf16 v[112:115], v[140:143], v[208:211], v[112:115]
  v_cvt_pk_bf16_f32 v166, v100, v101
  v_cvt_pk_bf16_f32 v167, v102, v103
  s_waitcnt lgkmcnt(3)
  v_mfma_f32_16x16x32_bf16 v[116:119], v[136:139], v[216:219], v[116:119]
  buffer_store_dwordx4 v[164:167], v11, s[48:51], s89 offen offset:0 sc1
  v_mfma_f32_16x16x32_bf16 v[116:119], v[140:143], v[212:215], v[116:119]
  s_waitcnt lgkmcnt(2)
  v_mfma_f32_16x16x32_bf16 v[120:123], v[136:139], v[220:223], v[120:123]
  v_cvt_pk_bf16_f32 v168, v104, v105
  v_cvt_pk_bf16_f32 v169, v106, v107
  v_mfma_f32_16x16x32_bf16 v[120:123], v[140:143], v[216:219], v[120:123]
  v_cvt_pk_bf16_f32 v170, v108, v109
  v_cvt_pk_bf16_f32 v171, v110, v111
  s_waitcnt lgkmcnt(1)
  v_mfma_f32_16x16x32_bf16 v[124:127], v[136:139], v[224:227], v[124:127]
  buffer_store_dwordx4 v[168:171], v11, s[48:51], s89 offen offset:1024 sc1
  v_mfma_f32_16x16x32_bf16 v[124:127], v[140:143], v[220:223], v[124:127]
  v_cvt_pk_bf16_f32 v172, v112, v113
  v_cvt_pk_bf16_f32 v173, v114, v115
  v_cvt_pk_bf16_f32 v174, v116, v117
  v_cvt_pk_bf16_f32 v175, v118, v119
  buffer_store_dwordx4 v[172:175], v11, s[48:51], s89 offen offset:2048 sc1
  v_cvt_pk_bf16_f32 v176, v120, v121
  v_cvt_pk_bf16_f32 v177, v122, v123
  s_nop 0
  v_cvt_pk_bf16_f32 v178, v124, v125
  v_cvt_pk_bf16_f32 v179, v126, v127
  buffer_store_dwordx4 v[176:179], v11, s[48:51], s89 offen offset:3072 sc1
  s_mul_i32 s95, s93, 8448
  s_add_u32 s95, s95, 794624
  s_waitcnt vmcnt(0)
  s_mov_b64 exec, 1
  ds_add_rtn_u32 v4, v14, v15 offset:72
  s_mov_b64 exec, -1
  s_waitcnt lgkmcnt(0)
  v_readfirstlane_b32 s70, v4
  s_nop 0
  s_cmp_lg_u32 s70, 3
  s_cbranch_scc1 L_arr_5
  buffer_atomic_add v15, v7, s[48:51], s95 offen sc1
L_arr_5:
  ds_write_b128 v20, v[40:43] offset:0
  ds_write_b128 v20, v[44:47] offset:1024
  ds_write_b128 v20, v[48:51] offset:2048
  ds_write_b128 v20, v[52:55] offset:3072
  ds_write_b128 v20, v[56:59] offset:4096
  ds_write_b128 v20, v[60:63] offset:5120
  ds_write_b128 v20, v[64:67] offset:6144
  ds_write_b128 v20, v[68:71] offset:7168
  s_mov_b64 exec, 1
  ds_add_u32 v14, v15 offset:52
  s_mov_b64 exec, -1
  v_lshrrev_b32 v4, 2, v2
  v_and_b32 v5, 3, v2
  v_lshlrev_b32 v6, 4, v5
  v_and_b32 v6, 7, v2
  v_lshlrev_b32 v6, 4, v6
  v_lshl_add_u32 v32, v3, 12, v6
  v_and_b32_e64 v6, 1, v2
  v_mul_u32_u24 v6, 4608, v6
  v_and_b32_e64 v37, 3, v4
  v_lshl_add_u32 v6, v37, 7, v6
  s_and_b32 s88, s64, 1
  s_mul_i32 s88, s88, 4544
  s_sub_u32 s88, s92, s88
  s_xor_b32 s89, s64, 1
  s_lshl_b32 s89, s89, 2
  v_add_u32 v33, s89, v14
  v_and_b32 v37, 48, v2
  v_and_b32_e64 v38, 2, v2
  v_lshl_add_u32 v37, v38, 2, v37
  v_add3_u32 v34, v6, v37, s88
  v_and_b32 v6, 8, v2
  v_and_b32 v37, 48, v2
  v_lshl_add_u32 v6, v6, 5, v37
  v_and_b32 v38, 7, v2
  v_lshlrev_b32 v38, 4, v38
  v_lshl_add_u32 v35, v6, 12, v38
  s_and_b32 s89, s64, 1
  s_lshl1_add_u32 s89, s94, s89
  s_lshl_b32 s89, s89, 11
  s_and_b32 s99, s64, 2
  s_lshl2_add_u32 s99, s93, s99
  s_add_u32 s99, s99, s89
  s_lshl_b32 s99, s99, 6
  s_mul_i32 s89, s94, 8448
  s_add_u32 s89, s89, 794624
  s_cmp_lg_u32 s70, 3
  s_cbranch_scc1 L_pollo_8
  s_mov_b32 s96, 200000
  v_mov_b32 v4, 0
  buffer_atomic_add v4, v7, s[48:51], s89 offen sc0 sc1
L_poll_6:
  s_waitcnt vmcnt(0)
  v_readfirstlane_b32 s71, v4
  s_nop 0
  s_cmp_ge_u32 s71, 16
  s_cbranch_scc1 L_polld_7
  v_mov_b32 v4, 0
  buffer_atomic_add v4, v7, s[48:51], s89 offen sc0 sc1
  s_sub_u32 s96, s96, 1
  s_cbranch_scc0 L_poll_6
L_polld_7:
  ds_write_b32 v14, v15 offset:76
  s_branch L_polle_9
L_pollo_8:
L_lpoll_10:
  ds_read_b32 v4, v14 offset:76
  s_waitcnt lgkmcnt(0)
  v_cmp_ne_u32 vcc, 1, v4
  s_nop 0
  s_cbranch_vccnz L_lpoll_10
L_polle_9:
L_lpoll_11:
  s_waitcnt vmcnt(0)
  ds_read_b32 v4, v27 offset:80
  s_waitcnt lgkmcnt(0)
  v_cmp_ne_u32_e64 vcc, 1, v4
  s_nop 0
  s_cbranch_vccnz L_lpoll_11
  s_add_u32 m0, s92, 0
  s_add_u32 s89, s99, 8388608
  buffer_load_dwordx4 v32, s[48:51], s89 offen sc1 lds
  s_add_u32 m0, s92, 1056
  s_add_u32 s89, s99, 8421376
  buffer_load_dwordx4 v32, s[48:51], s89 offen sc1 lds
  s_add_u32 m0, s92, 2112
  s_add_u32 s89, s99, 8454144
  buffer_load_dwordx4 v32, s[48:51], s89 offen sc1 lds
  s_add_u32 m0, s92, 3168
  s_add_u32 s89, s99, 8486912
  buffer_load_dwordx4 v32, s[48:51], s89 offen sc1 lds
  s_lshr_b32 s88, s93, 2
  s_lshl3_add_u32 s88, s88, s64
  s_and_b32 s89, s93, 3
  s_lshl4_add_u32 s88, s88, s89
  s_lshl_b32 s88, s88, 7
  s_add_u32 s88, s88, s94
  s_lshl_b32 s88, s88, 7
  s_waitcnt vmcnt(0)
  ds_write_b32 v27, v15 offset:144
L_lpoll_12:
  ds_read_b32 v4, v33 offset:144
  s_waitcnt lgkmcnt(0)
  v_cmp_ne_u32 vcc, 1, v4
  s_nop 0
  s_cbranch_vccnz L_lpoll_12
  ds_read_b64_tr_b16 v[56:57], v34 offset:0
  ds_read_b64_tr_b16 v[58:59], v34 offset:512
  ds_read_b64_tr_b16 v[60:61], v34 offset:1056
  ds_read_b64_tr_b16 v[62:63], v34 offset:1568
  ds_read_b64_tr_b16 v[64:65], v34 offset:2112
  ds_read_b64_tr_b16 v[66:67], v34 offset:2624
  ds_read_b64_tr_b16 v[68:69], v34 offset:3168
  ds_read_b64_tr_b16 v[70:71], v34 offset:3680
  s_mov_b32 vcc_lo, 0x55555555
  s_mov_b32 vcc_hi, 0x55555555
  s_waitcnt lgkmcnt(5)
  v_cndmask_b32_dpp v72, v60, v56, vcc quad_perm:[1,0,3,2] row_mask:0xf bank_mask:0xf
  v_cndmask_b32_dpp v73, v61, v57, vcc quad_perm:[1,0,3,2] row_mask:0xf bank_mask:0xf
  s_waitcnt lgkmcnt(4)
  v_cndmask_b32_dpp v74, v62, v58, vcc quad_perm:[1,0,3,2] row_mask:0xf bank_mask:0xf
  v_cndmask_b32_dpp v75, v63, v59, vcc quad_perm:[1,0,3,2] row_mask:0xf bank_mask:0xf
  s_waitcnt lgkmcnt(1)
  v_cndmask_b32_dpp v80, v68, v64, vcc quad_perm:[1,0,3,2] row_mask:0xf bank_mask:0xf
  v_cndmask_b32_dpp v81, v69, v65, vcc quad_perm:[1,0,3,2] row_mask:0xf bank_mask:0xf
  s_waitcnt lgkmcnt(0)
  v_cndmask_b32_dpp v82, v70, v66, vcc quad_perm:[1,0,3,2] row_mask:0xf bank_mask:0xf
  v_cndmask_b32_dpp v83, v71, v67, vcc quad_perm:[1,0,3,2] row_mask:0xf bank_mask:0xf
  s_not_b64 vcc, vcc
  v_cndmask_b32_dpp v76, v56, v60, vcc quad_perm:[1,0,3,2] row_mask:0xf bank_mask:0xf
  v_cndmask_b32_dpp v77, v57, v61, vcc quad_perm:[1,0,3,2] row_mask:0xf bank_mask:0xf
  v_cndmask_b32_dpp v78, v58, v62, vcc quad_perm:[1,0,3,2] row_mask:0xf bank_mask:0xf
  v_cndmask_b32_dpp v79, v59, v63, vcc quad_perm:[1,0,3,2] row_mask:0xf bank_mask:0xf
  v_cndmask_b32_dpp v84, v64, v68, vcc quad_perm:[1,0,3,2] row_mask:0xf bank_mask:0xf
  v_cndmask_b32_dpp v85, v65, v69, vcc quad_perm:[1,0,3,2] row_mask:0xf bank_mask:0xf
  v_cndmask_b32_dpp v86, v66, v70, vcc quad_perm:[1,0,3,2] row_mask:0xf bank_mask:0xf
  v_cndmask_b32_dpp v87, v67, v71, vcc quad_perm:[1,0,3,2] row_mask:0xf bank_mask:0xf
  s_mov_b32 vcc_lo, 0x33333333
  s_mov_b32 vcc_hi, 0x33333333
  v_cndmask_b32_dpp v56, v80, v72, vcc quad_perm:[2,3,0,1] row_mask:0xf bank_mask:0xf
  v_cndmask_b32_dpp v57, v81, v73, vcc quad_perm:[2,3,0,1] row_mask:0xf bank_mask:0xf
  v_cndmask_b32_dpp v58, v82, v74, vcc quad_perm:[2,3,0,1] row_mask:0xf bank_mask:0xf
  v_cndmask_b32_dpp v59, v83, v75, vcc quad_perm:[2,3,0,1] row_mask:0xf bank_mask:0xf
  v_cndmask_b32_dpp v60, v84, v76, vcc quad_perm:[2,3,0,1] row_mask:0xf bank_mask:0xf
  v_cndmask_b32_dpp v61, v85, v77, vcc quad_perm:[2,3,0,1] row_mask:0xf bank_mask:0xf
  v_cndmask_b32_dpp v62, v86, v78, vcc quad_perm:[2,3,0,1] row_mask:0xf bank_mask:0xf
  v_cndmask_b32_dpp v63, v87, v79, vcc quad_perm:[2,3,0,1] row_mask:0xf bank_mask:0xf
  s_not_b64 vcc, vcc
  v_cndmask_b32_dpp v64, v72, v80, vcc quad_perm:[2,3,0,1] row_mask:0xf bank_mask:0xf
  v_cndmask_b32_dpp v65, v73, v81, vcc quad_perm:[2,3,0,1] row_mask:0xf bank_mask:0xf
  v_cndmask_b32_dpp v66, v74, v82, vcc quad_perm:[2,3,0,1] row_mask:0xf bank_mask:0xf
  v_cndmask_b32_dpp v67, v75, v83, vcc quad_perm:[2,3,0,1] row_mask:0xf bank_mask:0xf
  v_cndmask_b32_dpp v68, v76, v84, vcc quad_perm:[2,3,0,1] row_mask:0xf bank_mask:0xf
  v_cndmask_b32_dpp v69, v77, v85, vcc quad_perm:[2,3,0,1] row_mask:0xf bank_mask:0xf
  v_cndmask_b32_dpp v70, v78, v86, vcc quad_perm:[2,3,0,1] row_mask:0xf bank_mask:0xf
  v_cndmask_b32_dpp v71, v79, v87, vcc quad_perm:[2,3,0,1] row_mask:0xf bank_mask:0xf
  s_add_u32 s89, s88, 0
  buffer_store_dwordx4 v[56:59], v35, s[52:55], s89 offen offset:2048 nt
  s_add_u32 s89, s88, 4096
  buffer_store_dwordx4 v[60:63], v35, s[52:55], s89 offen offset:2048 nt
  s_add_u32 s89, s88, 8192
  buffer_store_dwordx4 v[64:67], v35, s[52:55], s89 offen offset:2048 nt
  s_add_u32 s89, s88, 12288
  buffer_store_dwordx4 v[68:71], v35, s[52:55], s89 offen offset:2048 nt
  s_endpgm
L_compute:
  v_lshlrev_b32 v3, 2, v2
  v_mov_b32 v5, 0
  ds_write_b32 v3, v5 offset:34816
  s_and_b32 s4, s2, 1
  s_bfe_u32 s88, s2, 0x30003
  s_lshl3_add_u32 s4, s4, s88
  s_bfe_u32 s5, s2, 0x20001
  s_lshr_b32 s88, s2, 6
  s_lshl2_add_u32 s5, s5, s88
  s_bfe_u32 s6, s2, 0x20001
  s_bfe_u32 s88, s2, 0x20003
  s_lshl2_add_u32 s6, s6, s88
  s_and_b32 s7, s2, 1
  s_lshr_b32 s88, s2, 5
  s_lshl3_add_u32 s7, s7, s88
  s_mul_i32 s92, s3, 8704
  s_and_b32 s64, s3, 1
  s_lshr_b32 s65, s3, 1
  v_and_b32 v3, 15, v2
  v_lshrrev_b32 v4, 4, v2
  v_lshrrev_b32 v5, 1, v3
  v_xor_b32 v5, v5, v4
  v_lshlrev_b32_e64 v5, 4, v5
  v_lshl_add_u32 v5, v3, 7, v5
  s_lshl_b32 s88, s65, 13
  v_add_u32 v246, s88, v5
  v_xor_b32_e64 v247, 64, v246
  v_bfe_u32 v3, v2, 2, 2
  v_lshl_add_u32 v5, v4, 3, v3
  v_lshlrev_b32 v5, 7, v5
  v_lshrrev_b32 v3, 1, v3
  v_xor_b32 v6, s64, v4
  v_and_b32 v6, 1, v6
  v_lshl_add_u32 v3, v6, 1, v3
  v_lshl_add_u32 v5, v3, 5, v5
  v_and_b32_e64 v3, 3, v2
  v_lshl_add_u32 v5, v3, 3, v5
  v_add_u32 v252, 16384, v5
  v_xor_b32 v253, 32, v252
  s_lshl_b32 s88, s65, 5
  v_xor_b32 v254, s88, v252
  v_xor_b32 v255, s88, v253
  s_mov_b32 s90, 0x358637bd
  s_mov_b32 s91, 0x3fb8aa3b
  s_mov_b32 s48, s36
  s_mov_b32 s49, s37
  s_mov_b32 s50, 20971520
  s_mov_b32 s51, 0x20000
  s_mov_b32 s52, s32
  s_mov_b32 s53, s33
  s_mov_b32 s54, 8388608
  s_mov_b32 s55, 0x20000
  s_lshl1_add_u32 s98, s5, s64
  s_lshl1_add_u32 s96, s98, s65
  s_lshr_b32 s88, s4, 2
  s_lshl2_add_u32 s39, s96, s88
  s_lshl_b32 s39, s39, 8
  s_and_b32 s88, s4, 3
  s_lshl2_add_u32 s39, s88, s39
  s_add_u32 s39, s39, 65536
  s_lshl_b32 s96, s96, 14
  s_add_u32 s96, s96, 1048576
  s_lshl_b32 s38, s4, 10
  s_add_u32 s38, s38, s96
  s_mul_i32 s95, s5, 8448
  s_add_u32 s95, s95, 524288
  v_lshlrev_b32_e64 v5, 4, v2
  v_lshl_add_u32 v6, v4, 26, v5
  v_mov_b32 v240, -1
  v_mov_b32 v241, -1
  v_mov_b32 v242, -1
  v_mov_b32 v243, -1
  buffer_store_dwordx4 v[240:243], v5, s[48:51], s38 offen sc1
  buffer_store_dword v240, v6, s[48:51], s39 offen sc1
  v_mov_b32_e64 v97, 1
  s_mov_b32 s66, 40960
  s_mov_b32 s67, 1
  v_add_u32 v244, s66, v246
  v_add_u32 v245, s66, v247
  v_add_u32 v248, s66, v252
  v_add_u32 v249, s66, v253
  v_add_u32 v250, s66, v254
  v_add_u32 v251, s66, v255
  s_cmp_eq_u32 s64, 0
  s_mov_b32 s88, 36864
  s_cselect_b32 s88, 118784, s88
  s_lshl_b32 s89, s65, 11
  s_add_u32 s88, s88, s89
  v_mov_b32 v206, 34816
  v_lshlrev_b32 v197, 4, v2
  v_add_u32 v198, s88, v197
  v_lshl_add_u32 v199, v1, 2, v206
  v_and_b32_e64 v3, 15, v2
  v_lshl_add_u32 v5, v1, 4, v3
  v_lshlrev_b32_e64 v98, 2, v5
  v_lshl_add_u32 v204, v4, 26, v197
  v_lshlrev_b32_e64 v205, 26, v2
  v_xor_b32 v207, 2048, v198
  v_xor_b32_e64 v96, 8, v199
  v_xor_b32 v99, 128, v98
  v_mul_u32_u24 v196, 2304, v2
  v_lshrrev_b32_e64 v5, 2, v2
  v_lshl_add_u32 v196, v5, 26, v196
  v_lshlrev_b32 v6, 2, v4
  v_sub_u32 v6, v3, v6
  v_cmp_gt_u32 vcc, 4, v6
  v_lshlrev_b32 v6, 4, v6
  v_mov_b32 v208, 0x3f80
  v_mov_b32 v209, 0
  v_cndmask_b32 v208, v209, v208, vcc
  v_lshlrev_b64 v[210:211], v6, v[208:209]
  v_mov_b32 v208, 0
  v_mov_b32 v212, 0
  v_mov_b32 v213, 0
  v_mov_b32 v228, 1
  s_mov_b32 s88, 0x3f803f80
  s_mov_b32 s89, 0x35863586
  s_mov_b32 s93, 0x3b0637bd
  v_mov_b32 v200, s88
  v_mov_b32 v201, s88
  v_mov_b32 v202, s88
  v_mov_b32 v203, s88
  v_mov_b32 v220, s89
  v_mov_b32 v221, s89
  v_mov_b32 v222, s89
  v_mov_b32 v223, s89
  v_mov_b32 v224, s93
  v_mov_b32 v225, s93
  v_mov_b32 v226, s93
  v_mov_b32 v227, s93
L_pad_2:
  s_cmp_eq_u32 s101, 1
  s_cbranch_scc1 L_res_c
  v_mov_b32 v216, s90
  v_mov_b32 v217, s90
  v_mov_b32 v218, s90
  v_mov_b32_e64 v219, s90
  s_and_b32 s89, s4, 3
  s_mul_i32 s89, s89, 2304
  s_add_u32 s89, s89, s95
  s_lshl_b32 s94, s98, 11
  s_add_u32 s94, s94, 65536
  s_lshl1_add_u32 s93, s4, s65
  s_lshl_b32 s93, s93, 7
  s_add_u32 s93, s93, s98
  s_lshl_b32 s93, s93, 10
  s_add_u32 s93, s93, 12582912
  v_and_b32_e64 v3, 15, v2
  v_mul_u32_u24 v5, 544, v3
  v_and_b32_e64 v6, 48, v2
  v_add3_u32 v70, v5, v6, s92
  v_max_u32 v6, 1, v4
  v_sub_u32 v6, 6, v6
  v_lshlrev_b32 v71, v6, v3
  v_mov_b32 v74, 16
  v_lshlrev_b32 v74, v6, v74
  v_lshlrev_b32 v6, 4, v4
  v_lshlrev_b32 v5, 9, v4
  v_cmp_gt_u32 vcc, 2, v4
  v_lshl_add_u32 v73, v3, 2, v5
  v_add_u32 v73, s92, v73
  v_cndmask_b32 v6, v5, v6, vcc
  v_add3_u32 v71, v71, v6, s92
  v_cmp_eq_u32 vcc, 3, v4
  v_mov_b32 v6, 8
  v_mov_b32 v5, 256
  v_cndmask_b32 v6, v6, v5, vcc
  v_add_u32 v72, v71, v6
  v_add_u32 v75, v71, v74
  v_add_u32 v76, v72, v74
  v_lshl_add_u32 v78, v2, 3, s92
  v_lshl_add_u32 v79, v2, 2, s92
  v_mov_b32 v77, 0
  s_mov_b32 m0, s92
  v_mov_b32 v132, 0x3f80
  v_mov_b32 v133, 0x3f80
  v_cmp_eq_u32 vcc, 0, v2
  s_waitcnt vmcnt(9)
  v_lshlrev_b32_e64 v68, 16, v86
  v_mul_f32 v68, 0x3fb8aa3b, v68
  v_exp_f32 v68, v68
  s_waitcnt vmcnt(8)
  v_lshlrev_b32_e64 v8, 16, v80
  v_and_b32 v38, 0xffff0000, v80
  s_waitcnt vmcnt(7)
  v_lshlrev_b32 v9, 16, v81
  v_and_b32 v39, 0xffff0000, v81
  v_cvt_pk_bf16_f32 v68, v68, v68
  v_lshlrev_b32 v68, 16, v68
  s_waitcnt vmcnt(6)
  v_lshlrev_b32_e64 v10, 16, v82
  v_and_b32 v40, 0xffff0000, v82
  s_waitcnt vmcnt(5)
  v_lshlrev_b32 v11, 16, v83
  v_and_b32 v41, 0xffff0000, v83
  s_waitcnt vmcnt(4)
  v_lshlrev_b32 v12, 16, v84
  v_and_b32 v42, 0xffff0000, v84
  s_waitcnt vmcnt(3)
  v_lshlrev_b32 v13, 16, v85
  v_and_b32 v43, 0xffff0000, v85
  s_lshr_b32 s88, s2, 2
  s_or_b32 s88, s88, s3
  s_cbranch_scc1 L_noflag
  s_waitcnt vmcnt(2)
  v_mov_b32 v5, 0
  v_mov_b32_e64 v6, 1
  s_mov_b64 exec, 1
  global_atomic_add v5, v6, s[34:35] sc1
  s_mov_b64 exec, -1
L_noflag:
  v_pk_mul_f32 v[8:9], v[8:9], v[68:69] op_sel_hi:[1,0]
  v_pk_mul_f32 v[38:39], v[38:39], v[68:69] op_sel_hi:[1,0]
  v_pk_mul_f32 v[10:11], v[10:11], v[68:69] op_sel_hi:[1,0]
  v_pk_mul_f32 v[40:41], v[40:41], v[68:69] op_sel_hi:[1,0]
  v_mul_f32 v8, 0x3fb8aa3b, v8
  v_mul_f32 v9, 0x3e22f983, v9
  v_mul_f32 v38, 0x3fb8aa3b, v38
  v_mul_f32 v39, 0x3e22f983, v39
  v_fract_f32 v33, v9
  v_exp_f32 v32, v8
  v_fract_f32 v63, v39
  v_exp_f32 v62, v38
  v_cos_f32 v14, v33
  v_sin_f32 v15, v33
  v_cos_f32 v44, v63
  v_sin_f32_e64 v45, v63
  v_mul_f32 v34, 0x41000000, v8
  v_mul_f32 v35, 0x41000000, v9
  v_mul_f32 v64, 0x41000000, v38
  v_mul_f32 v65, 0x41000000, v39
  v_fract_f32 v35, v35
  v_exp_f32 v34, v34
  v_fract_f32 v65, v65
  v_exp_f32 v64, v64
  v_cos_f32 v16, v35
  v_sin_f32 v17, v35
  v_cos_f32 v46, v65
  v_sin_f32 v47, v65
  v_mul_f32 v36, 0x43800000, v8
  v_mul_f32 v37, 0x43800000, v9
  v_mul_f32 v66, 0x43800000, v38
  v_mul_f32 v67, 0x43800000, v39
  v_fract_f32 v37, v37
  v_exp_f32 v36, v36
  v_fract_f32 v67, v67
  v_exp_f32 v66, v66
  v_cos_f32 v18, v37
  v_sin_f32 v19, v37
  v_cos_f32 v48, v67
  v_sin_f32 v49, v67
  v_pk_mul_f32 v[20:21], v[12:13], v[10:11] op_sel_hi:[1,0]
  v_pk_mul_f32 v[50:51], v[42:43], v[40:41] op_sel_hi:[1,0]
  v_pk_fma_f32 v[20:21], v[12:13], v[10:11], v[20:21] op_sel:[1,1,0] op_sel_hi:[0,1,1] neg_lo:[1,0,0]
  v_pk_fma_f32 v[50:51], v[42:43], v[40:41], v[50:51] op_sel:[1,1,0] op_sel_hi:[0,1,1] neg_lo:[1,0,0]
  v_pk_mul_f32 v[14:15], v[14:15], v[32:33] op_sel_hi:[1,0]
  v_pk_mul_f32 v[44:45], v[44:45], v[62:63] op_sel_hi:[1,0]
  v_pk_mul_f32 v[16:17], v[16:17], v[34:35] op_sel_hi:[1,0]
  v_pk_mul_f32 v[46:47], v[46:47], v[64:65] op_sel_hi:[1,0]
  v_pk_mul_f32 v[18:19], v[18:19], v[36:37] op_sel_hi:[1,0]
  v_pk_mul_f32 v[48:49], v[48:49], v[66:67] op_sel_hi:[1,0]
  v_pk_mul_f32 v[28:29], v[20:21], v[14:15] op_sel_hi:[1,0]
  v_pk_mul_f32 v[58:59], v[50:51], v[44:45] op_sel_hi:[1,0]
  v_cvt_pk_bf16_f32 v100, v20, -v21
  v_cvt_pk_bf16_f32 v101, v50, -v51
  v_pk_fma_f32 v[28:29], v[20:21], v[14:15], v[28:29] op_sel:[1,1,0] op_sel_hi:[0,1,1] neg_lo:[1,0,0]
  v_pk_fma_f32 v[58:59], v[50:51], v[44:45], v[58:59] op_sel:[1,1,0] op_sel_hi:[0,1,1] neg_lo:[1,0,0]
  v_pk_mul_f32 v[22:23], v[28:29], v[14:15] op_sel_hi:[1,0]
  v_pk_mul_f32 v[52:53], v[58:59], v[44:45] op_sel_hi:[1,0]
  v_cvt_pk_bf16_f32 v102, v28, -v29
  v_cvt_pk_bf16_f32 v103, v58, -v59
  v_pk_fma_f32 v[22:23], v[28:29], v[14:15], v[22:23] op_sel:[1,1,0] op_sel_hi:[0,1,1] neg_lo:[1,0,0]
  v_pk_fma_f32 v[52:53], v[58:59], v[44:45], v[52:53] op_sel:[1,1,0] op_sel_hi:[0,1,1] neg_lo:[1,0,0]
  v_pk_mul_f32 v[28:29], v[22:23], v[14:15] op_sel_hi:[1,0]
  v_pk_mul_f32 v[58:59], v[52:53], v[44:45] op_sel_hi:[1,0]
  v_cvt_pk_bf16_f32 v104, v22, -v23
  v_cvt_pk_bf16_f32 v105, v52, -v53
  v_pk_fma_f32 v[28:29], v[22:23], v[14:15], v[28:29] op_sel:[1,1,0] op_sel_hi:[0,1,1] neg_lo:[1,0,0]
  v_pk_fma_f32 v[58:59], v[52:53], v[44:45], v[58:59] op_sel:[1,1,0] op_sel_hi:[0,1,1] neg_lo:[1,0,0]
  v_pk_mul_f32 v[24:25], v[28:29], v[14:15] op_sel_hi:[1,0]
  v_pk_mul_f32 v[54:55], v[58:59], v[44:45] op_sel_hi:[1,0]
  v_cvt_pk_bf16_f32 v106, v28, -v29
  v_cvt_pk_bf16_f32 v107, v58, -v59
  v_pk_fma_f32 v[24:25], v[28:29], v[14:15], v[24:25] op_sel:[1,1,0] op_sel_hi:[0,1,1] neg_lo:[1,0,0]
  v_pk_fma_f32 v[54:55], v[58:59], v[44:45], v[54:55] op_sel:[1,1,0] op_sel_hi:[0,1,1] neg_lo:[1,0,0]
  v_pk_mul_f32 v[28:29], v[24:25], v[14:15] op_sel_hi:[1,0]
  v_pk_mul_f32 v[58:59], v[54:55], v[44:45] op_sel_hi:[1,0]
  v_cvt_pk_bf16_f32 v108, v24, -v25
  v_cvt_pk_bf16_f32 v109, v54, -v55
  v_pk_fma_f32 v[28:29], v[24:25], v[14:15], v[28:29] op_sel:[1,1,0] op_sel_hi:[0,1,1] neg_lo:[1,0,0]
  v_pk_fma_f32 v[58:59], v[54:55], v[44:45], v[58:59] op_sel:[1,1,0] op_sel_hi:[0,1,1] neg_lo:[1,0,0]
  v_pk_mul_f32 v[26:27], v[28:29], v[14:15] op_sel_hi:[1,0]
  v_pk_mul_f32 v[56:57], v[58:59], v[44:45] op_sel_hi:[1,0]
  v_cvt_pk_bf16_f32 v110, v28, -v29
  v_cvt_pk_bf16_f32 v111, v58, -v59
  v_pk_fma_f32 v[26:27], v[28:29], v[14:15], v[26:27] op_sel:[1,1,0] op_sel_hi:[0,1,1] neg_lo:[1,0,0]
  v_pk_fma_f32 v[56:57], v[58:59], v[44:45], v[56:57] op_sel:[1,1,0] op_sel_hi:[0,1,1] neg_lo:[1,0,0]
  v_pk_mul_f32 v[28:29], v[26:27], v[14:15] op_sel_hi:[1,0]
  v_pk_mul_f32 v[58:59], v[56:57], v[44:45] op_sel_hi:[1,0]
  v_cvt_pk_bf16_f32 v112, v26, -v27
  v_cvt_pk_bf16_f32 v113, v56, -v57
  v_pk_fma_f32 v[28:29], v[26:27], v[14:15], v[28:29] op_sel:[1,1,0] op_sel_hi:[0,1,1] neg_lo:[1,0,0]
  v_pk_fma_f32 v[58:59], v[56:57], v[44:45], v[58:59] op_sel:[1,1,0] op_sel_hi:[0,1,1] neg_lo:[1,0,0]
  v_pk_mul_f32 v[32:33], v[22:23], v[18:19] op_sel_hi:[1,0]
  v_pk_mul_f32 v[62:63], v[52:53], v[48:49] op_sel_hi:[1,0]
  v_cvt_pk_bf16_f32 v114, v28, -v29
  v_cvt_pk_bf16_f32 v115, v58, -v59
  v_pk_fma_f32 v[32:33], v[22:23], v[18:19], v[32:33] op_sel:[1,1,0] op_sel_hi:[0,1,1] neg_lo:[1,0,0]
  v_pk_fma_f32 v[62:63], v[52:53], v[48:49], v[62:63] op_sel:[1,1,0] op_sel_hi:[0,1,1] neg_lo:[1,0,0]
  v_pk_mul_f32 v[28:29], v[20:21], v[18:19] op_sel_hi:[1,0]
  v_pk_mul_f32 v[58:59], v[50:51], v[48:49] op_sel_hi:[1,0]
  v_cvt_pk_bf16_f32 v118, v32, -v33
  v_cvt_pk_bf16_f32 v119, v62, -v63
  v_pk_fma_f32 v[28:29], v[20:21], v[18:19], v[28:29] op_sel:[1,1,0] op_sel_hi:[0,1,1] neg_lo:[1,0,0]
  v_pk_fma_f32 v[58:59], v[50:51], v[48:49], v[58:59] op_sel:[1,1,0] op_sel_hi:[0,1,1] neg_lo:[1,0,0]
  v_pk_mul_f32 v[32:33], v[26:27], v[18:19] op_sel_hi:[1,0]
  v_pk_mul_f32 v[62:63], v[56:57], v[48:49] op_sel_hi:[1,0]
  v_cvt_pk_bf16_f32 v116, v28, -v29
  v_cvt_pk_bf16_f32 v117, v58, -v59
  v_pk_fma_f32 v[32:33], v[26:27], v[18:19], v[32:33] op_sel:[1,1,0] op_sel_hi:[0,1,1] neg_lo:[1,0,0]
  v_pk_fma_f32 v[62:63], v[56:57], v[48:49], v[62:63] op_sel:[1,1,0] op_sel_hi:[0,1,1] neg_lo:[1,0,0]
  v_pk_mul_f32 v[30:31], v[24:25], v[18:19] op_sel_hi:[1,0]
  v_pk_mul_f32 v[60:61], v[54:55], v[48:49] op_sel_hi:[1,0]
  v_cvt_pk_bf16_f32 v122, v32, -v33
  v_cvt_pk_bf16_f32 v123, v62, -v63
  v_pk_fma_f32 v[30:31], v[24:25], v[18:19], v[30:31] op_sel:[1,1,0] op_sel_hi:[0,1,1] neg_lo:[1,0,0]
  v_pk_fma_f32 v[60:61], v[54:55], v[48:49], v[60:61] op_sel:[1,1,0] op_sel_hi:[0,1,1] neg_lo:[1,0,0]
  v_pk_mul_f32 v[20:21], v[28:29], v[18:19] op_sel_hi:[1,0]
  v_pk_mul_f32 v[50:51], v[58:59], v[48:49] op_sel_hi:[1,0]
  v_cvt_pk_bf16_f32 v120, v30, -v31
  v_cvt_pk_bf16_f32 v121, v60, -v61
  v_pk_fma_f32 v[20:21], v[28:29], v[18:19], v[20:21] op_sel:[1,1,0] op_sel_hi:[0,1,1] neg_lo:[1,0,0]
  v_pk_fma_f32 v[50:51], v[58:59], v[48:49], v[50:51] op_sel:[1,1,0] op_sel_hi:[0,1,1] neg_lo:[1,0,0]
  v_pk_mul_f32 v[24:25], v[30:31], v[18:19] op_sel_hi:[1,0]
  v_pk_mul_f32 v[54:55], v[60:61], v[48:49] op_sel_hi:[1,0]
  v_cvt_pk_bf16_f32 v124, v20, -v21
  v_cvt_pk_bf16_f32 v125, v50, -v51
  v_pk_fma_f32 v[24:25], v[30:31], v[18:19], v[24:25] op_sel:[1,1,0] op_sel_hi:[0,1,1] neg_lo:[1,0,0]
  v_pk_fma_f32 v[54:55], v[60:61], v[48:49], v[54:55] op_sel:[1,1,0] op_sel_hi:[0,1,1] neg_lo:[1,0,0]
  v_pk_mul_f32 v[28:29], v[20:21], v[18:19] op_sel_hi:[1,0]
  v_pk_mul_f32 v[58:59], v[50:51], v[48:49] op_sel_hi:[1,0]
  v_cvt_pk_bf16_f32 v126, v24, -v25
  v_cvt_pk_bf16_f32 v127, v54, -v55
  v_pk_fma_f32 v[28:29], v[20:21], v[18:19], v[28:29] op_sel:[1,1,0] op_sel_hi:[0,1,1] neg_lo:[1,0,0]
  v_pk_fma_f32 v[58:59], v[50:51], v[48:49], v[58:59] op_sel:[1,1,0] op_sel_hi:[0,1,1] neg_lo:[1,0,0]
  v_pk_mul_f32 v[30:31], v[24:25], v[18:19] op_sel_hi:[1,0]
  v_pk_mul_f32 v[60:61], v[54:55], v[48:49] op_sel_hi:[1,0]
  v_cvt_pk_bf16_f32 v128, v28, -v29
  v_cvt_pk_bf16_f32 v129, v58, -v59
  v_pk_fma_f32 v[30:31], v[24:25], v[18:19], v[30:31] op_sel:[1,1,0] op_sel_hi:[0,1,1] neg_lo:[1,0,0]
  v_pk_fma_f32 v[60:61], v[54:55], v[48:49], v[60:61] op_sel:[1,1,0] op_sel_hi:[0,1,1] neg_lo:[1,0,0]
  v_pk_mul_f32 v[20:21], v[28:29], v[18:19] op_sel_hi:[1,0]
  v_pk_mul_f32 v[50:51], v[58:59], v[48:49] op_sel_hi:[1,0]
  v_cvt_pk_bf16_f32 v130, v30, -v31
  v_cvt_pk_bf16_f32 v131, v60, -v61
  v_pk_fma_f32 v[20:21], v[28:29], v[18:19], v[20:21] op_sel:[1,1,0] op_sel_hi:[0,1,1] neg_lo:[1,0,0]
  v_pk_fma_f32 v[50:51], v[58:59], v[48:49], v[50:51] op_sel:[1,1,0] op_sel_hi:[0,1,1] neg_lo:[1,0,0]
  v_pk_mul_f32 v[28:29], v[20:21], v[18:19] op_sel_hi:[1,0]
  v_pk_mul_f32 v[58:59], v[50:51], v[48:49] op_sel_hi:[1,0]
  v_cvt_pk_bf16_f32 v230, v20, -v21
  v_cvt_pk_bf16_f32 v231, v50, -v51
  v_pk_fma_f32 v[28:29], v[20:21], v[18:19], v[28:29] op_sel:[1,1,0] op_sel_hi:[0,1,1] neg_lo:[1,0,0]
  v_pk_fma_f32 v[58:59], v[50:51], v[48:49], v[58:59] op_sel:[1,1,0] op_sel_hi:[0,1,1] neg_lo:[1,0,0]
  v_pk_mul_f32 v[20:21], v[28:29], v[18:19] op_sel_hi:[1,0]
  v_pk_mul_f32 v[50:51], v[58:59], v[48:49] op_sel_hi:[1,0]
  v_cvt_pk_bf16_f32 v232, v28, -v29
  v_cvt_pk_bf16_f32 v233, v58, -v59
  v_pk_fma_f32 v[20:21], v[28:29], v[18:19], v[20:21] op_sel:[1,1,0] op_sel_hi:[0,1,1] neg_lo:[1,0,0]
  v_pk_fma_f32 v[50:51], v[58:59], v[48:49], v[50:51] op_sel:[1,1,0] op_sel_hi:[0,1,1] neg_lo:[1,0,0]
  v_pk_mul_f32 v[28:29], v[20:21], v[18:19] op_sel_hi:[1,0]
  v_pk_mul_f32 v[58:59], v[50:51], v[48:49] op_sel_hi:[1,0]
  v_cvt_pk_bf16_f32 v234, v20, -v21
  v_cvt_pk_bf16_f32 v235, v50, -v51
  v_pk_fma_f32 v[28:29], v[20:21], v[18:19], v[28:29] op_sel:[1,1,0] op_sel_hi:[0,1,1] neg_lo:[1,0,0]
  v_pk_fma_f32 v[58:59], v[50:51], v[48:49], v[58:59] op_sel:[1,1,0] op_sel_hi:[0,1,1] neg_lo:[1,0,0]
  v_pk_mul_f32 v[20:21], v[28:29], v[18:19] op_sel_hi:[1,0]
  v_pk_mul_f32 v[50:51], v[58:59], v[48:49] op_sel_hi:[1,0]
  v_cvt_pk_bf16_f32 v236, v28, -v29
  v_cvt_pk_bf16_f32 v237, v58, -v59
  v_pk_fma_f32 v[20:21], v[28:29], v[18:19], v[20:21] op_sel:[1,1,0] op_sel_hi:[0,1,1] neg_lo:[1,0,0]
  v_pk_fma_f32 v[50:51], v[58:59], v[48:49], v[50:51] op_sel:[1,1,0] op_sel_hi:[0,1,1] neg_lo:[1,0,0]
  v_pk_mul_f32 v[28:29], v[16:17], v[16:17] op_sel_hi:[1,0]
  v_pk_mul_f32 v[58:59], v[46:47], v[46:47] op_sel_hi:[1,0]
  v_cvt_pk_bf16_f32 v238, v20, -v21
  v_cvt_pk_bf16_f32 v239, v50, -v51
  v_cvt_pk_bf16_f32 v134, v16, v17
  v_cvt_pk_bf16_f32 v135, v46, v47
  v_pk_fma_f32 v[28:29], v[16:17], v[16:17], v[28:29] op_sel:[1,1,0] op_sel_hi:[0,1,1] neg_lo:[1,0,0]
  v_pk_fma_f32 v[58:59], v[46:47], v[46:47], v[58:59] op_sel:[1,1,0] op_sel_hi:[0,1,1] neg_lo:[1,0,0]
  v_pk_mul_f32 v[30:31], v[28:29], v[16:17] op_sel_hi:[1,0]
  v_pk_mul_f32 v[60:61], v[58:59], v[46:47] op_sel_hi:[1,0]
  v_cvt_pk_bf16_f32 v136, v28, v29
  v_cvt_pk_bf16_f32 v137, v58, v59
  v_pk_fma_f32 v[30:31], v[28:29], v[16:17], v[30:31] op_sel:[1,1,0] op_sel_hi:[0,1,1] neg_lo:[1,0,0]
  v_pk_fma_f32 v[60:61], v[58:59], v[46:47], v[60:61] op_sel:[1,1,0] op_sel_hi:[0,1,1] neg_lo:[1,0,0]
  v_pk_mul_f32 v[28:29], v[30:31], v[16:17] op_sel_hi:[1,0]
  v_pk_mul_f32 v[58:59], v[60:61], v[46:47] op_sel_hi:[1,0]
  v_cvt_pk_bf16_f32 v138, v30, v31
  v_cvt_pk_bf16_f32 v139, v60, v61
  v_pk_fma_f32 v[28:29], v[30:31], v[16:17], v[28:29] op_sel:[1,1,0] op_sel_hi:[0,1,1] neg_lo:[1,0,0]
  v_pk_fma_f32 v[58:59], v[60:61], v[46:47], v[58:59] op_sel:[1,1,0] op_sel_hi:[0,1,1] neg_lo:[1,0,0]
  v_pk_mul_f32 v[30:31], v[28:29], v[16:17] op_sel_hi:[1,0]
  v_pk_mul_f32 v[60:61], v[58:59], v[46:47] op_sel_hi:[1,0]
  v_cvt_pk_bf16_f32 v140, v28, v29
  v_cvt_pk_bf16_f32 v141, v58, v59
  v_pk_fma_f32 v[30:31], v[28:29], v[16:17], v[30:31] op_sel:[1,1,0] op_sel_hi:[0,1,1] neg_lo:[1,0,0]
  v_pk_fma_f32 v[60:61], v[58:59], v[46:47], v[60:61] op_sel:[1,1,0] op_sel_hi:[0,1,1] neg_lo:[1,0,0]
  v_pk_mul_f32 v[28:29], v[30:31], v[16:17] op_sel_hi:[1,0]
  v_pk_mul_f32 v[58:59], v[60:61], v[46:47] op_sel_hi:[1,0]
  v_cvt_pk_bf16_f32 v142, v30, v31
  v_cvt_pk_bf16_f32 v143, v60, v61
  v_pk_fma_f32 v[28:29], v[30:31], v[16:17], v[28:29] op_sel:[1,1,0] op_sel_hi:[0,1,1] neg_lo:[1,0,0]
  v_pk_fma_f32 v[58:59], v[60:61], v[46:47], v[58:59] op_sel:[1,1,0] op_sel_hi:[0,1,1] neg_lo:[1,0,0]
  v_pk_mul_f32 v[30:31], v[28:29], v[16:17] op_sel_hi:[1,0]
  v_pk_mul_f32 v[60:61], v[58:59], v[46:47] op_sel_hi:[1,0]
  v_cvt_pk_bf16_f32 v144, v28, v29
  v_cvt_pk_bf16_f32 v145, v58, v59
  v_pk_fma_f32 v[30:31], v[28:29], v[16:17], v[30:31] op_sel:[1,1,0] op_sel_hi:[0,1,1] neg_lo:[1,0,0]
  v_pk_fma_f32 v[60:61], v[58:59], v[46:47], v[60:61] op_sel:[1,1,0] op_sel_hi:[0,1,1] neg_lo:[1,0,0]
  v_pk_mul_f32 v[28:29], v[30:31], v[16:17] op_sel_hi:[1,0]
  v_pk_mul_f32 v[58:59], v[60:61], v[46:47] op_sel_hi:[1,0]
  v_cvt_pk_bf16_f32 v146, v30, v31
  v_cvt_pk_bf16_f32 v147, v60, v61
  v_pk_fma_f32 v[28:29], v[30:31], v[16:17], v[28:29] op_sel:[1,1,0] op_sel_hi:[0,1,1] neg_lo:[1,0,0]
  v_pk_fma_f32 v[58:59], v[60:61], v[46:47], v[58:59] op_sel:[1,1,0] op_sel_hi:[0,1,1] neg_lo:[1,0,0]
  v_pk_mul_f32 v[30:31], v[28:29], v[16:17] op_sel_hi:[1,0]
  v_pk_mul_f32 v[60:61], v[58:59], v[46:47] op_sel_hi:[1,0]
  v_cvt_pk_bf16_f32 v148, v28, v29
  v_cvt_pk_bf16_f32 v149, v58, v59
  v_pk_fma_f32 v[30:31], v[28:29], v[16:17], v[30:31] op_sel:[1,1,0] op_sel_hi:[0,1,1] neg_lo:[1,0,0]
  v_pk_fma_f32 v[60:61], v[58:59], v[46:47], v[60:61] op_sel:[1,1,0] op_sel_hi:[0,1,1] neg_lo:[1,0,0]
  v_pk_mul_f32 v[28:29], v[30:31], v[16:17] op_sel_hi:[1,0]
  v_pk_mul_f32 v[58:59], v[60:61], v[46:47] op_sel_hi:[1,0]
  v_cvt_pk_bf16_f32 v150, v30, v31
  v_cvt_pk_bf16_f32 v151, v60, v61
  v_pk_fma_f32 v[28:29], v[30:31], v[16:17], v[28:29] op_sel:[1,1,0] op_sel_hi:[0,1,1] neg_lo:[1,0,0]
  v_pk_fma_f32 v[58:59], v[60:61], v[46:47], v[58:59] op_sel:[1,1,0] op_sel_hi:[0,1,1] neg_lo:[1,0,0]
  v_pk_mul_f32 v[30:31], v[28:29], v[16:17] op_sel_hi:[1,0]
  v_pk_mul_f32 v[60:61], v[58:59], v[46:47] op_sel_hi:[1,0]
  v_cvt_pk_bf16_f32 v152, v28, v29
  v_cvt_pk_bf16_f32 v153, v58, v59
  v_pk_fma_f32 v[30:31], v[28:29], v[16:17], v[30:31] op_sel:[1,1,0] op_sel_hi:[0,1,1] neg_lo:[1,0,0]
  v_pk_fma_f32 v[60:61], v[58:59], v[46:47], v[60:61] op_sel:[1,1,0] op_sel_hi:[0,1,1] neg_lo:[1,0,0]
  v_pk_mul_f32 v[28:29], v[30:31], v[16:17] op_sel_hi:[1,0]
  v_pk_mul_f32 v[58:59], v[60:61], v[46:47] op_sel_hi:[1,0]
  v_cvt_pk_bf16_f32 v154, v30, v31
  v_cvt_pk_bf16_f32 v155, v60, v61
  v_pk_fma_f32 v[28:29], v[30:31], v[16:17], v[28:29] op_sel:[1,1,0] op_sel_hi:[0,1,1] neg_lo:[1,0,0]
  v_pk_fma_f32 v[58:59], v[60:61], v[46:47], v[58:59] op_sel:[1,1,0] op_sel_hi:[0,1,1] neg_lo:[1,0,0]
  v_pk_mul_f32 v[30:31], v[28:29], v[16:17] op_sel_hi:[1,0]
  v_pk_mul_f32 v[60:61], v[58:59], v[46:47] op_sel_hi:[1,0]
  v_cvt_pk_bf16_f32 v156, v28, v29
  v_cvt_pk_bf16_f32 v157, v58, v59
  v_pk_fma_f32 v[30:31], v[28:29], v[16:17], v[30:31] op_sel:[1,1,0] op_sel_hi:[0,1,1] neg_lo:[1,0,0]
  v_pk_fma_f32 v[60:61], v[58:59], v[46:47], v[60:61] op_sel:[1,1,0] op_sel_hi:[0,1,1] neg_lo:[1,0,0]
  v_pk_mul_f32 v[28:29], v[30:31], v[16:17] op_sel_hi:[1,0]
  v_pk_mul_f32 v[58:59], v[60:61], v[46:47] op_sel_hi:[1,0]
  v_cvt_pk_bf16_f32 v158, v30, v31
  v_cvt_pk_bf16_f32 v159, v60, v61
  v_pk_fma_f32 v[28:29], v[30:31], v[16:17], v[28:29] op_sel:[1,1,0] op_sel_hi:[0,1,1] neg_lo:[1,0,0]
  v_pk_fma_f32 v[58:59], v[60:61], v[46:47], v[58:59] op_sel:[1,1,0] op_sel_hi:[0,1,1] neg_lo:[1,0,0]
  v_pk_mul_f32 v[30:31], v[28:29], v[16:17] op_sel_hi:[1,0]
  v_pk_mul_f32 v[60:61], v[58:59], v[46:47] op_sel_hi:[1,0]
  v_cvt_pk_bf16_f32 v160, v28, v29
  v_cvt_pk_bf16_f32 v161, v58, v59
  v_pk_fma_f32 v[30:31], v[28:29], v[16:17], v[30:31] op_sel:[1,1,0] op_sel_hi:[0,1,1] neg_lo:[1,0,0]
  v_pk_fma_f32 v[60:61], v[58:59], v[46:47], v[60:61] op_sel:[1,1,0] op_sel_hi:[0,1,1] neg_lo:[1,0,0]
  v_pk_mul_f32 v[28:29], v[30:31], v[16:17] op_sel_hi:[1,0]
  v_pk_mul_f32 v[58:59], v[60:61], v[46:47] op_sel_hi:[1,0]
  v_cvt_pk_bf16_f32 v162, v30, v31
  v_cvt_pk_bf16_f32 v163, v60, v61
  v_pk_fma_f32 v[28:29], v[30:31], v[16:17], v[28:29] op_sel:[1,1,0] op_sel_hi:[0,1,1] neg_lo:[1,0,0]
  v_pk_fma_f32 v[58:59], v[60:61], v[46:47], v[58:59] op_sel:[1,1,0] op_sel_hi:[0,1,1] neg_lo:[1,0,0]
  v_pk_mul_f32 v[30:31], v[28:29], v[16:17] op_sel_hi:[1,0]
  v_pk_mul_f32 v[60:61], v[58:59], v[46:47] op_sel_hi:[1,0]
  v_cvt_pk_bf16_f32 v164, v28, v29
  v_cvt_pk_bf16_f32 v165, v58, v59
  v_pk_fma_f32 v[30:31], v[28:29], v[16:17], v[30:31] op_sel:[1,1,0] op_sel_hi:[0,1,1] neg_lo:[1,0,0]
  v_pk_fma_f32 v[60:61], v[58:59], v[46:47], v[60:61] op_sel:[1,1,0] op_sel_hi:[0,1,1] neg_lo:[1,0,0]
  v_pk_mul_f32 v[28:29], v[30:31], v[16:17] op_sel_hi:[1,0]
  v_pk_mul_f32 v[58:59], v[60:61], v[46:47] op_sel_hi:[1,0]
  v_cvt_pk_bf16_f32 v166, v30, v31
  v_cvt_pk_bf16_f32 v167, v60, v61
  v_pk_fma_f32 v[28:29], v[30:31], v[16:17], v[28:29] op_sel:[1,1,0] op_sel_hi:[0,1,1] neg_lo:[1,0,0]
  v_pk_fma_f32 v[58:59], v[60:61], v[46:47], v[58:59] op_sel:[1,1,0] op_sel_hi:[0,1,1] neg_lo:[1,0,0]
  v_pk_mul_f32 v[30:31], v[28:29], v[16:17] op_sel_hi:[1,0]
  v_pk_mul_f32 v[60:61], v[58:59], v[46:47] op_sel_hi:[1,0]
  v_cvt_pk_bf16_f32 v168, v28, v29
  v_cvt_pk_bf16_f32 v169, v58, v59
  v_pk_fma_f32 v[30:31], v[28:29], v[16:17], v[30:31] op_sel:[1,1,0] op_sel_hi:[0,1,1] neg_lo:[1,0,0]
  v_pk_fma_f32 v[60:61], v[58:59], v[46:47], v[60:61] op_sel:[1,1,0] op_sel_hi:[0,1,1] neg_lo:[1,0,0]
  v_pk_mul_f32 v[28:29], v[30:31], v[16:17] op_sel_hi:[1,0]
  v_pk_mul_f32 v[58:59], v[60:61], v[46:47] op_sel_hi:[1,0]
  v_cvt_pk_bf16_f32 v170, v30, v31
  v_cvt_pk_bf16_f32 v171, v60, v61
  v_pk_fma_f32 v[28:29], v[30:31], v[16:17], v[28:29] op_sel:[1,1,0] op_sel_hi:[0,1,1] neg_lo:[1,0,0]
  v_pk_fma_f32 v[58:59], v[60:61], v[46:47], v[58:59] op_sel:[1,1,0] op_sel_hi:[0,1,1] neg_lo:[1,0,0]
  v_pk_mul_f32 v[30:31], v[28:29], v[16:17] op_sel_hi:[1,0]
  v_pk_mul_f32 v[60:61], v[58:59], v[46:47] op_sel_hi:[1,0]
  v_cvt_pk_bf16_f32 v172, v28, v29
  v_cvt_pk_bf16_f32 v173, v58, v59
  v_pk_fma_f32 v[30:31], v[28:29], v[16:17], v[30:31] op_sel:[1,1,0] op_sel_hi:[0,1,1] neg_lo:[1,0,0]
  v_pk_fma_f32 v[60:61], v[58:59], v[46:47], v[60:61] op_sel:[1,1,0] op_sel_hi:[0,1,1] neg_lo:[1,0,0]
  v_pk_mul_f32 v[28:29], v[30:31], v[16:17] op_sel_hi:[1,0]
  v_pk_mul_f32 v[58:59], v[60:61], v[46:47] op_sel_hi:[1,0]
  v_cvt_pk_bf16_f32 v174, v30, v31
  v_cvt_pk_bf16_f32 v175, v60, v61
  v_pk_fma_f32 v[28:29], v[30:31], v[16:17], v[28:29] op_sel:[1,1,0] op_sel_hi:[0,1,1] neg_lo:[1,0,0]
  v_pk_fma_f32 v[58:59], v[60:61], v[46:47], v[58:59] op_sel:[1,1,0] op_sel_hi:[0,1,1] neg_lo:[1,0,0]
  v_pk_mul_f32 v[30:31], v[28:29], v[16:17] op_sel_hi:[1,0]
  v_pk_mul_f32 v[60:61], v[58:59], v[46:47] op_sel_hi:[1,0]
  v_cvt_pk_bf16_f32 v176, v28, v29
  v_cvt_pk_bf16_f32 v177, v58, v59
  v_pk_fma_f32 v[30:31], v[28:29], v[16:17], v[30:31] op_sel:[1,1,0] op_sel_hi:[0,1,1] neg_lo:[1,0,0]
  v_pk_fma_f32 v[60:61], v[58:59], v[46:47], v[60:61] op_sel:[1,1,0] op_sel_hi:[0,1,1] neg_lo:[1,0,0]
  v_pk_mul_f32 v[28:29], v[30:31], v[16:17] op_sel_hi:[1,0]
  v_pk_mul_f32 v[58:59], v[60:61], v[46:47] op_sel_hi:[1,0]
  v_cvt_pk_bf16_f32 v178, v30, v31
  v_cvt_pk_bf16_f32 v179, v60, v61
  v_pk_fma_f32 v[28:29], v[30:31], v[16:17], v[28:29] op_sel:[1,1,0] op_sel_hi:[0,1,1] neg_lo:[1,0,0]
  v_pk_fma_f32 v[58:59], v[60:61], v[46:47], v[58:59] op_sel:[1,1,0] op_sel_hi:[0,1,1] neg_lo:[1,0,0]
  v_pk_mul_f32 v[30:31], v[28:29], v[16:17] op_sel_hi:[1,0]
  v_pk_mul_f32 v[60:61], v[58:59], v[46:47] op_sel_hi:[1,0]
  v_cvt_pk_bf16_f32 v180, v28, v29
  v_cvt_pk_bf16_f32 v181, v58, v59
  v_pk_fma_f32 v[30:31], v[28:29], v[16:17], v[30:31] op_sel:[1,1,0] op_sel_hi:[0,1,1] neg_lo:[1,0,0]
  v_pk_fma_f32 v[60:61], v[58:59], v[46:47], v[60:61] op_sel:[1,1,0] op_sel_hi:[0,1,1] neg_lo:[1,0,0]
  v_pk_mul_f32 v[28:29], v[30:31], v[16:17] op_sel_hi:[1,0]
  v_pk_mul_f32 v[58:59], v[60:61], v[46:47] op_sel_hi:[1,0]
  v_cvt_pk_bf16_f32 v182, v30, v31
  v_cvt_pk_bf16_f32 v183, v60, v61
  v_pk_fma_f32 v[28:29], v[30:31], v[16:17], v[28:29] op_sel:[1,1,0] op_sel_hi:[0,1,1] neg_lo:[1,0,0]
  v_pk_fma_f32 v[58:59], v[60:61], v[46:47], v[58:59] op_sel:[1,1,0] op_sel_hi:[0,1,1] neg_lo:[1,0,0]
  v_pk_mul_f32 v[30:31], v[28:29], v[16:17] op_sel_hi:[1,0]
  v_pk_mul_f32 v[60:61], v[58:59], v[46:47] op_sel_hi:[1,0]
  v_cvt_pk_bf16_f32 v184, v28, v29
  v_cvt_pk_bf16_f32 v185, v58, v59
  v_pk_fma_f32 v[30:31], v[28:29], v[16:17], v[30:31] op_sel:[1,1,0] op_sel_hi:[0,1,1] neg_lo:[1,0,0]
  v_pk_fma_f32 v[60:61], v[58:59], v[46:47], v[60:61] op_sel:[1,1,0] op_sel_hi:[0,1,1] neg_lo:[1,0,0]
  v_pk_mul_f32 v[28:29], v[30:31], v[16:17] op_sel_hi:[1,0]
  v_pk_mul_f32 v[58:59], v[60:61], v[46:47] op_sel_hi:[1,0]
  v_cvt_pk_bf16_f32 v186, v30, v31
  v_cvt_pk_bf16_f32 v187, v60, v61
  v_pk_fma_f32 v[28:29], v[30:31], v[16:17], v[28:29] op_sel:[1,1,0] op_sel_hi:[0,1,1] neg_lo:[1,0,0]
  v_pk_fma_f32 v[58:59], v[60:61], v[46:47], v[58:59] op_sel:[1,1,0] op_sel_hi:[0,1,1] neg_lo:[1,0,0]
  v_pk_mul_f32 v[30:31], v[28:29], v[16:17] op_sel_hi:[1,0]
  v_pk_mul_f32 v[60:61], v[58:59], v[46:47] op_sel_hi:[1,0]
  v_cvt_pk_bf16_f32 v188, v28, v29
  v_cvt_pk_bf16_f32 v189, v58, v59
  v_pk_fma_f32 v[30:31], v[28:29], v[16:17], v[30:31] op_sel:[1,1,0] op_sel_hi:[0,1,1] neg_lo:[1,0,0]
  v_pk_fma_f32 v[60:61], v[58:59], v[46:47], v[60:61] op_sel:[1,1,0] op_sel_hi:[0,1,1] neg_lo:[1,0,0]
  v_pk_mul_f32 v[28:29], v[30:31], v[16:17] op_sel_hi:[1,0]
  v_pk_mul_f32 v[58:59], v[60:61], v[46:47] op_sel_hi:[1,0]
  v_cvt_pk_bf16_f32 v190, v30, v31
  v_cvt_pk_bf16_f32 v191, v60, v61
  v_pk_fma_f32 v[28:29], v[30:31], v[16:17], v[28:29] op_sel:[1,1,0] op_sel_hi:[0,1,1] neg_lo:[1,0,0]
  v_pk_fma_f32 v[58:59], v[60:61], v[46:47], v[58:59] op_sel:[1,1,0] op_sel_hi:[0,1,1] neg_lo:[1,0,0]
  v_pk_mul_f32 v[30:31], v[28:29], v[16:17] op_sel_hi:[1,0]
  v_pk_mul_f32 v[60:61], v[58:59], v[46:47] op_sel_hi:[1,0]
  v_cvt_pk_bf16_f32 v192, v28, v29
  v_cvt_pk_bf16_f32 v193, v58, v59
  v_pk_fma_f32 v[30:31], v[28:29], v[16:17], v[30:31] op_sel:[1,1,0] op_sel_hi:[0,1,1] neg_lo:[1,0,0]
  v_pk_fma_f32 v[60:61], v[58:59], v[46:47], v[60:61] op_sel:[1,1,0] op_sel_hi:[0,1,1] neg_lo:[1,0,0]
  s_waitcnt vmcnt(2)
  v_lshlrev_b32 v87, 16, v87
  v_mov_b32_e64 v6, 0
  v_cvt_pk_bf16_f32 v194, v30, v31
  v_cvt_pk_bf16_f32 v195, v60, v61
  v_cndmask_b32_e64 v87, v6, v87, vcc
  ds_write_addtid_b32 v100 offset:0
  ds_write_addtid_b32 v101 offset:256
  ds_write_addtid_b32 v102 offset:544
  ds_write_addtid_b32 v103 offset:800
  ds_write_addtid_b32 v104 offset:1088
  ds_write_addtid_b32 v105 offset:1344
  ds_write_addtid_b32 v106 offset:1632
  ds_write_addtid_b32 v107 offset:1888
  ds_write_addtid_b32 v108 offset:2176
  ds_write_addtid_b32 v109 offset:2432
  ds_write_addtid_b32 v110 offset:2720
  ds_write_addtid_b32 v111 offset:2976
  ds_write_addtid_b32 v112 offset:3264
  ds_write_addtid_b32 v113 offset:3520
  ds_write_addtid_b32 v114 offset:3808
  ds_write_addtid_b32 v115 offset:4064
  ds_write_addtid_b32 v118 offset:4896
  ds_write_addtid_b32 v119 offset:5152
  ds_write_addtid_b32 v116 offset:4352
  ds_write_addtid_b32 v117 offset:4608
  ds_write_addtid_b32 v122 offset:5984
  ds_write_addtid_b32 v123 offset:6240
  ds_write_addtid_b32 v120 offset:5440
  ds_write_addtid_b32 v121 offset:5696
  ds_write_addtid_b32 v124 offset:6528
  ds_write_addtid_b32 v125 offset:6784
  ds_write_addtid_b32 v126 offset:7072
  ds_write_addtid_b32 v127 offset:7328
  ds_write_addtid_b32 v128 offset:7616
  ds_write_addtid_b32 v129 offset:7872
  ds_write_addtid_b32 v130 offset:8160
  ds_write_addtid_b32 v131 offset:8416
  ds_read_b128 v[100:103], v70 offset:0
  ds_read_b128 v[104:107], v70 offset:64
  ds_read_b128 v[108:111], v70 offset:128
  ds_read_b128 v[112:115], v70 offset:192
  ds_read_b128 v[116:119], v70 offset:256
  ds_read_b128 v[120:123], v70 offset:320
  ds_read_b128 v[124:127], v70 offset:384
  ds_read_b128 v[128:131], v70 offset:448
  ds_write_addtid_b32 v230 offset:0
  ds_write_addtid_b32 v231 offset:256
  ds_write_addtid_b32 v232 offset:544
  ds_write_addtid_b32 v233 offset:800
  ds_write_addtid_b32 v234 offset:1088
  ds_write_addtid_b32 v235 offset:1344
  ds_write_addtid_b32 v236 offset:1632
  ds_write_addtid_b32 v237 offset:1888
  ds_write_addtid_b32 v238 offset:2176
  ds_write_addtid_b32 v239 offset:2432
  ds_read_b128 v[12:15], v70 offset:0
  ds_read_b128 v[16:19], v70 offset:64
  ds_read_b128 v[20:23], v70 offset:128
  ds_read_b128 v[24:27], v70 offset:192
  ds_read_b128 v[28:31], v70 offset:256
  ds_read_b128 v[32:35], v70 offset:320
  ds_read_b128 v[36:39], v70 offset:384
  ds_read_b128 v[40:43], v70 offset:448
  ds_write_addtid_b32 v132 offset:0
  ds_write_addtid_b32 v133 offset:256
  ds_write_addtid_b32 v134 offset:544
  ds_write_addtid_b32 v135 offset:800
  ds_write_addtid_b32 v136 offset:1088
  ds_write_addtid_b32 v137 offset:1344
  ds_write_addtid_b32 v138 offset:1632
  ds_write_addtid_b32 v139 offset:1888
  ds_write_addtid_b32 v140 offset:2176
  ds_write_addtid_b32 v141 offset:2432
  ds_write_addtid_b32 v142 offset:2720
  ds_write_addtid_b32 v143 offset:2976
  ds_write_addtid_b32 v144 offset:3264
  ds_write_addtid_b32 v145 offset:3520
  ds_write_addtid_b32 v146 offset:3808
  ds_write_addtid_b32 v147 offset:4064
  ds_write_addtid_b32 v148 offset:4352
  ds_write_addtid_b32 v149 offset:4608
  ds_write_addtid_b32 v150 offset:4896
  ds_write_addtid_b32 v151 offset:5152
  ds_write_addtid_b32 v152 offset:5440
  ds_write_addtid_b32 v153 offset:5696
  ds_write_addtid_b32 v154 offset:5984
  ds_write_addtid_b32 v155 offset:6240
  ds_write_addtid_b32 v156 offset:6528
  ds_write_addtid_b32 v157 offset:6784
  ds_write_addtid_b32 v158 offset:7072
  ds_write_addtid_b32 v159 offset:7328
  ds_write_addtid_b32 v160 offset:7616
  ds_write_addtid_b32 v161 offset:7872
  ds_write_addtid_b32 v162 offset:8160
  ds_write_addtid_b32 v163 offset:8416
  ds_read_b128 v[132:135], v70 offset:0
  ds_read_b128 v[136:139], v70 offset:64
  ds_read_b128 v[140:143], v70 offset:128
  ds_read_b128 v[144:147], v70 offset:192
  ds_read_b128 v[148:151], v70 offset:256
  ds_read_b128 v[152:155], v70 offset:320
  ds_read_b128 v[156:159], v70 offset:384
  ds_read_b128 v[160:163], v70 offset:448
  ds_write_addtid_b32 v164 offset:0
  ds_write_addtid_b32 v165 offset:256
  ds_write_addtid_b32 v166 offset:544
  ds_write_addtid_b32 v167 offset:800
  ds_write_addtid_b32 v168 offset:1088
  ds_write_addtid_b32 v169 offset:1344
  s_waitcnt lgkmcnt(13)
  v_mfma_f32_16x16x32_bf16 v[44:47], v[100:103], v[132:135], 0
  ds_write_addtid_b32 v170 offset:1632
  ds_write_addtid_b32 v171 offset:1888
  ds_write_addtid_b32 v172 offset:2176
  s_waitcnt lgkmcnt(14)
  v_mfma_f32_16x16x32_bf16 v[44:47], v[104:107], v[136:139], v[44:47]
  ds_write_addtid_b32 v173 offset:2432
  ds_write_addtid_b32 v174 offset:2720
  ds_write_addtid_b32 v175 offset:2976
  v_mfma_f32_16x16x32_bf16 v[44:47], v[108:111], v[140:143], v[44:47]
L_pad_3:
  s_cmp_eq_u32 s101, 1
  s_cbranch_scc1 L_res_c
  ds_write_addtid_b32 v176 offset:3264
  ds_write_addtid_b32 v177 offset:3520
  ds_write_addtid_b32 v178 offset:3808
  s_waitcnt lgkmcnt(14)
  v_mfma_f32_16x16x32_bf16 v[44:47], v[112:115], v[144:147], v[44:47]
  ds_write_addtid_b32 v179 offset:4064
  ds_write_addtid_b32 v180 offset:4352
  ds_write_addtid_b32 v181 offset:4608
  v_mfma_f32_16x16x32_bf16 v[44:47], v[116:119], v[148:151], v[44:47]
  ds_write_addtid_b32 v182 offset:4896
  ds_write_addtid_b32 v183 offset:5152
  ds_write_addtid_b32 v184 offset:5440
  v_mfma_f32_16x16x32_bf16 v[44:47], v[120:123], v[152:155], v[44:47]
  ds_write_addtid_b32 v185 offset:5696
  ds_write_addtid_b32 v186 offset:5984
  ds_write_addtid_b32 v187 offset:6240
  v_mfma_f32_16x16x32_bf16 v[44:47], v[124:127], v[156:159], v[44:47]
  ds_write_addtid_b32 v188 offset:6528
  ds_write_addtid_b32 v189 offset:6784
  ds_write_addtid_b32 v190 offset:7072
  v_mfma_f32_16x16x32_bf16 v[44:47], v[128:131], v[160:163], v[44:47]
  ds_write_addtid_b32 v191 offset:7328
  ds_write_addtid_b32 v192 offset:7616
  ds_write_addtid_b32 v193 offset:7872
  v_mfma_f32_16x16x32_bf16 v[52:55], v[12:15], v[132:135], 0
  ds_write_addtid_b32 v194 offset:8160
  ds_write_addtid_b32 v195 offset:8416
  ds_read_b128 v[164:167], v70 offset:0
  v_mfma_f32_16x16x32_bf16 v[52:55], v[16:19], v[136:139], v[52:55]
  ds_read_b128 v[168:171], v70 offset:64
  ds_read_b128 v[172:175], v70 offset:128
  ds_read_b128 v[176:179], v70 offset:192
  v_mfma_f32_16x16x32_bf16 v[52:55], v[20:23], v[140:143], v[52:55]
  ds_read_b128 v[180:183], v70 offset:256
  ds_read_b128 v[184:187], v70 offset:320
  ds_read_b128 v[188:191], v70 offset:384
  v_mfma_f32_16x16x32_bf16 v[52:55], v[24:27], v[144:147], v[52:55]
  ds_read_b128 v[192:195], v70 offset:448
  v_mfma_f32_16x16x32_bf16 v[52:55], v[28:31], v[148:151], v[52:55]
  v_mfma_f32_16x16x32_bf16 v[52:55], v[32:35], v[152:155], v[52:55]
  v_mfma_f32_16x16x32_bf16 v[52:55], v[36:39], v[156:159], v[52:55]
  v_mfma_f32_16x16x32_bf16 v[52:55], v[40:43], v[160:163], v[52:55]
  v_add_f32_e64 v44, v44, v87
  s_waitcnt lgkmcnt(7)
  v_mfma_f32_16x16x32_bf16 v[48:51], v[100:103], v[164:167], 0
  ds_write_b64 v71, v[44:45] offset:16
  s_waitcnt lgkmcnt(7)
  v_mfma_f32_16x16x32_bf16 v[48:51], v[104:107], v[168:171], v[48:51]
  s_waitcnt lgkmcnt(6)
  v_mfma_f32_16x16x32_bf16 v[48:51], v[108:111], v[172:175], v[48:51]
  ds_write_b64 v72, v[46:47] offset:16
  s_waitcnt lgkmcnt(6)
  v_mfma_f32_16x16x32_bf16 v[48:51], v[112:115], v[176:179], v[48:51]
  s_waitcnt lgkmcnt(5)
  v_mfma_f32_16x16x32_bf16 v[48:51], v[116:119], v[180:183], v[48:51]
  ds_write_b32 v73, v52 offset:2064
  s_waitcnt lgkmcnt(5)
  v_mfma_f32_16x16x32_bf16 v[48:51], v[120:123], v[184:187], v[48:51]
  s_waitcnt lgkmcnt(4)
  v_mfma_f32_16x16x32_bf16 v[48:51], v[124:127], v[188:191], v[48:51]
  ds_write_b32 v73, v53 offset:2192
  s_waitcnt lgkmcnt(4)
  v_mfma_f32_16x16x32_bf16 v[48:51], v[128:131], v[192:195], v[48:51]
  v_mfma_f32_16x16x32_bf16 v[56:59], v[12:15], v[164:167], 0
  ds_write_b32 v73, v54 offset:2320
  v_mfma_f32_16x16x32_bf16 v[56:59], v[16:19], v[168:171], v[56:59]
  v_mfma_f32_16x16x32_bf16 v[56:59], v[20:23], v[172:175], v[56:59]
  ds_write_b32 v73, v55 offset:2448
  v_mfma_f32_16x16x32_bf16 v[56:59], v[24:27], v[176:179], v[56:59]
  v_mfma_f32_16x16x32_bf16 v[56:59], v[28:31], v[180:183], v[56:59]
  ds_write_b32 v79, v77 offset:4608
  v_mfma_f32_16x16x32_bf16 v[56:59], v[32:35], v[184:187], v[56:59]
  v_mfma_f32_16x16x32_bf16 v[56:59], v[36:39], v[188:191], v[56:59]
  ds_write_b32 v79, v77 offset:4992
  v_mfma_f32_16x16x32_bf16 v[56:59], v[40:43], v[192:195], v[56:59]
  ds_write_b64 v75, v[48:49] offset:16
  ds_write_b64 v76, v[50:51] offset:16
  ds_read_b32 v8, v78 offset:1556
  ds_read_b32 v9, v78 offset:1560
  s_nop 3
  ds_write_b32 v73, v56 offset:2128
  ds_write_b32 v73, v57 offset:2256
  ds_write_b32 v73, v58 offset:2384
  ds_write_b32 v73, v59 offset:2512
  ds_read_b32 v10, v78 offset:2068
  ds_read_b32 v11, v78 offset:2072
  s_waitcnt lgkmcnt(6)
  v_cvt_pk_bf16_f32 v8, v8, v9
  ds_write_b32 v79, v8 offset:4736
  s_waitcnt lgkmcnt(1)
  v_cvt_pk_bf16_f32 v10, v10, v11
  ds_write_b32 v79, v10 offset:5120
  v_cmp_lt_u32 vcc, 1, v1
  s_waitcnt vmcnt(0) lgkmcnt(0)
  s_barrier
  s_setprio 3
  ds_read_b128 v[8:11], v244 offset:0
  ds_read_b64_tr_b16 v[72:73], v248 offset:8192
  ds_read_b64_tr_b16 v[74:75], v248 offset:8704
  ds_read_b128 v[24:27], v245 offset:0
  ds_read_b64_tr_b16 v[76:77], v248 offset:12288
  ds_read_b64_tr_b16 v[78:79], v248 offset:12800
  ds_read_b128 v[28:31], v245 offset:2048
  ds_read_b128 v[12:15], v244 offset:2048
  ds_read_b128 v[16:19], v244 offset:4096
  ds_read_b128 v[32:35], v245 offset:4096
  ds_read_b128 v[36:39], v245 offset:6144
  ds_read_b128 v[20:23], v244 offset:6144
  ds_read_b64_tr_b16 v[80:81], v249 offset:8192
  s_waitcnt lgkmcnt(10)
  v_mfma_f32_16x16x32_bf16 v[132:135], v[8:11], v[72:75], 1.0
  ds_read_b64_tr_b16 v[82:83], v249 offset:8704
  s_waitcnt lgkmcnt(8)
  v_mfma_f32_16x16x32_bf16 v[132:135], v[24:27], v[76:79], v[132:135]
  ds_read_b64_tr_b16 v[84:85], v249 offset:12288
  s_waitcnt lgkmcnt(8)
  v_mfma_f32_16x16x32_bf16 v[140:143], v[28:31], v[76:79], 1.0
  ds_read_b64_tr_b16 v[86:87], v249 offset:12800
  s_waitcnt lgkmcnt(8)
  v_mfma_f32_16x16x32_bf16 v[140:143], v[12:15], v[72:75], v[140:143]
  ds_read_b64_tr_b16 v[88:89], v250 offset:16384
  s_waitcnt lgkmcnt(5)
  v_mfma_f32_16x16x32_bf16 v[148:151], v[16:19], v[72:75], 1.0
  ds_read_b64_tr_b16 v[90:91], v250 offset:16896
  v_mfma_f32_16x16x32_bf16 v[148:151], v[32:35], v[76:79], v[148:151]
  ds_read_b64_tr_b16 v[92:93], v250 offset:20480
  v_mfma_f32_16x16x32_bf16 v[156:159], v[36:39], v[76:79], 1.0
  ds_read_b64_tr_b16 v[94:95], v250 offset:20992
  v_mfma_f32_16x16x32_bf16 v[156:159], v[20:23], v[72:75], v[156:159]
  s_waitcnt lgkmcnt(4)
  v_mfma_f32_16x16x32_bf16 v[160:163], v[20:23], v[80:83], 1.0
  ds_read_b64_tr_b16 v[72:73], v251 offset:16384
  v_mfma_f32_16x16x32_bf16 v[160:163], v[36:39], v[84:87], v[160:163]
  ds_read_b64_tr_b16 v[74:75], v251 offset:16896
  v_mfma_f32_16x16x32_bf16 v[152:155], v[32:35], v[84:87], 1.0
  ds_read_b64_tr_b16 v[76:77], v251 offset:20480
  v_mfma_f32_16x16x32_bf16 v[152:155], v[16:19], v[80:83], v[152:155]
  ds_read_b64_tr_b16 v[78:79], v251 offset:20992
  v_mfma_f32_16x16x32_bf16 v[144:147], v[12:15], v[80:83], 1.0
  s_add_u32 s66, s66, 40960
  v_mfma_f32_16x16x32_bf16 v[144:147], v[28:31], v[84:87], v[144:147]
  s_cmp_eq_u32 s66, 163840
  v_mfma_f32_16x16x32_bf16 v[136:139], v[24:27], v[84:87], 1.0
  s_cselect_b32 s66, 40960, s66
  v_mfma_f32_16x16x32_bf16 v[136:139], v[8:11], v[80:83], v[136:139]
  s_waitcnt lgkmcnt(4)
  v_mfma_f32_16x16x32_bf16 v[164:167], v[8:11], v[88:91], 0
  ds_read_b64_tr_b16 v[80:81], v248 offset:0
  v_mfma_f32_16x16x32_bf16 v[164:167], v[24:27], v[92:95], v[164:167]
  ds_read_b64_tr_b16 v[82:83], v248 offset:512
  v_mfma_f32_16x16x32_bf16 v[172:175], v[28:31], v[92:95], 0
  ds_read_b64_tr_b16 v[84:85], v248 offset:4096
  v_mfma_f32_16x16x32_bf16 v[172:175], v[12:15], v[88:91], v[172:175]
  ds_read_b64_tr_b16 v[86:87], v248 offset:4608
  v_mfma_f32_16x16x32_bf16 v[180:183], v[16:19], v[88:91], 0
  v_add_u32 v244, s66, v246
  v_mfma_f32_16x16x32_bf16 v[180:183], v[32:35], v[92:95], v[180:183]
  v_add_u32_e64 v245, s66, v247
  v_mfma_f32_16x16x32_bf16 v[188:191], v[36:39], v[92:95], 0
  v_add_u32_e64 v250, s66, v254
  v_mfma_f32_16x16x32_bf16 v[188:191], v[20:23], v[88:91], v[188:191]
  s_waitcnt lgkmcnt(4)
  v_mfma_f32_16x16x32_bf16 v[192:195], v[20:23], v[72:75], 0
  ds_read_b64_tr_b16 v[88:89], v249 offset:0
  v_mfma_f32_16x16x32_bf16 v[192:195], v[36:39], v[76:79], v[192:195]
  ds_read_b64_tr_b16 v[90:91], v249 offset:512
  v_mfma_f32_16x16x32_bf16 v[184:187], v[32:35], v[76:79], 0
  ds_read_b64_tr_b16 v[92:93], v249 offset:4096
  v_mfma_f32_16x16x32_bf16 v[184:187], v[16:19], v[72:75], v[184:187]
  ds_read_b64_tr_b16 v[94:95], v249 offset:4608
  v_mfma_f32_16x16x32_bf16 v[176:179], v[12:15], v[72:75], 0
  v_add_u32 v248, s66, v252
  v_mfma_f32_16x16x32_bf16 v[176:179], v[28:31], v[76:79], v[176:179]
  v_add_u32_e64 v249, s66, v253
  v_mfma_f32_16x16x32_bf16 v[168:171], v[24:27], v[76:79], 0
  v_add_u32_e64 v251, s66, v255
  v_mfma_f32_16x16x32_bf16 v[168:171], v[8:11], v[72:75], v[168:171]
  s_waitcnt lgkmcnt(4)
  v_mfma_f32_16x16x32_bf16 v[100:103], v[80:83], v[8:11], 1.0
  s_waitcnt lgkmcnt(0)
  v_mfma_f32_16x16x32_bf16 v[100:103], v[84:87], v[24:27], v[100:103]
  s_barrier
  v_mfma_f32_16x16x32_bf16 v[108:111], v[84:87], v[28:31], 1.0
  ds_read_b128 v[40:43], v244 offset:0
  v_mfma_f32_16x16x32_bf16 v[108:111], v[80:83], v[12:15], v[108:111]
  ds_read_b64_tr_b16 v[72:73], v248 offset:8192
  v_mfma_f32_16x16x32_bf16 v[116:119], v[80:83], v[16:19], 1.0
  ds_read_b64_tr_b16 v[74:75], v248 offset:8704
  v_mfma_f32_16x16x32_bf16 v[116:119], v[84:87], v[32:35], v[116:119]
  ds_read_b128 v[56:59], v245 offset:0
  v_mfma_f32_16x16x32_bf16 v[124:127], v[84:87], v[36:39], 1.0
  ds_read_b64_tr_b16 v[76:77], v248 offset:12288
  v_mfma_f32_16x16x32_bf16 v[124:127], v[80:83], v[20:23], v[124:127]
  ds_read_b64_tr_b16 v[78:79], v248 offset:12800
  v_mfma_f32_16x16x32_bf16 v[128:131], v[88:91], v[20:23], 1.0
  ds_read_b128 v[60:63], v245 offset:2048
  v_mfma_f32_16x16x32_bf16 v[128:131], v[92:95], v[36:39], v[128:131]
  ds_read_b128 v[44:47], v244 offset:2048
  v_mfma_f32_16x16x32_bf16 v[120:123], v[92:95], v[32:35], 1.0
  ds_read_b128 v[48:51], v244 offset:4096
  v_mfma_f32_16x16x32_bf16 v[120:123], v[88:91], v[16:19], v[120:123]
  ds_read_b128 v[64:67], v245 offset:4096
  v_mfma_f32_16x16x32_bf16 v[112:115], v[88:91], v[12:15], 1.0
  ds_read_b128 v[68:71], v245 offset:6144
  v_mfma_f32_16x16x32_bf16 v[112:115], v[92:95], v[28:31], v[112:115]
  ds_read_b128 v[52:55], v244 offset:6144
  v_mfma_f32_16x16x32_bf16 v[104:107], v[92:95], v[24:27], 1.0
  ds_read_b64_tr_b16 v[80:81], v249 offset:8192
  s_waitcnt lgkmcnt(5)
  v_mfma_f32_16x16x32_bf16 v[104:107], v[88:91], v[8:11], v[104:107]
.p2align 3
L_cloop:
  v_mfma_f32_16x16x32_bf16 v[132:135], v[40:43], v[72:75], v[132:135]
  ds_read_b64_tr_b16 v[82:83], v249 offset:8704
  v_mfma_f32_16x16x32_bf16 v[132:135], v[56:59], v[76:79], v[132:135]
  ds_read_b64_tr_b16 v[84:85], v249 offset:12288
  v_mfma_f32_16x16x32_bf16 v[140:143], v[60:63], v[76:79], v[140:143]
  ds_read_b64_tr_b16 v[86:87], v249 offset:12800
  v_mfma_f32_16x16x32_bf16 v[140:143], v[44:47], v[72:75], v[140:143]
  ds_read_b64_tr_b16 v[88:89], v250 offset:16384
  s_waitcnt lgkmcnt(5)
  v_mfma_f32_16x16x32_bf16 v[148:151], v[48:51], v[72:75], v[148:151]
  ds_read_b64_tr_b16 v[90:91], v250 offset:16896
  v_mfma_f32_16x16x32_bf16 v[148:151], v[64:67], v[76:79], v[148:151]
  ds_read_b64_tr_b16 v[92:93], v250 offset:20480
  v_mfma_f32_16x16x32_bf16 v[156:159], v[68:71], v[76:79], v[156:159]
  ds_read_b64_tr_b16 v[94:95], v250 offset:20992
  v_mfma_f32_16x16x32_bf16 v[156:159], v[52:55], v[72:75], v[156:159]
  s_waitcnt lgkmcnt(4)
  v_mfma_f32_16x16x32_bf16 v[160:163], v[52:55], v[80:83], v[160:163]
  ds_read_b64_tr_b16 v[72:73], v251 offset:16384
  v_mfma_f32_16x16x32_bf16 v[160:163], v[68:71], v[84:87], v[160:163]
  ds_read_b64_tr_b16 v[74:75], v251 offset:16896
  v_mfma_f32_16x16x32_bf16 v[152:155], v[64:67], v[84:87], v[152:155]
  ds_read_b64_tr_b16 v[76:77], v251 offset:20480
  v_mfma_f32_16x16x32_bf16 v[152:155], v[48:51], v[80:83], v[152:155]
  ds_read_b64_tr_b16 v[78:79], v251 offset:20992
  v_mfma_f32_16x16x32_bf16 v[144:147], v[44:47], v[80:83], v[144:147]
  s_add_u32 s66, s66, 40960
  v_mfma_f32_16x16x32_bf16 v[144:147], v[60:63], v[84:87], v[144:147]
  s_cmp_eq_u32 s66, 163840
  v_mfma_f32_16x16x32_bf16 v[136:139], v[56:59], v[84:87], v[136:139]
  s_cselect_b32 s66, 40960, s66
  v_mfma_f32_16x16x32_bf16 v[136:139], v[40:43], v[80:83], v[136:139]
  s_waitcnt lgkmcnt(4)
  v_mfma_f32_16x16x32_bf16 v[164:167], v[40:43], v[88:91], v[164:167]
  ds_read_b64_tr_b16 v[80:81], v248 offset:0
  v_mfma_f32_16x16x32_bf16 v[164:167], v[56:59], v[92:95], v[164:167]
  ds_read_b64_tr_b16 v[82:83], v248 offset:512
  v_mfma_f32_16x16x32_bf16 v[172:175], v[60:63], v[92:95], v[172:175]
  ds_read_b64_tr_b16 v[84:85], v248 offset:4096
  v_mfma_f32_16x16x32_bf16 v[172:175], v[44:47], v[88:91], v[172:175]
  ds_read_b64_tr_b16 v[86:87], v248 offset:4608
  v_mfma_f32_16x16x32_bf16 v[180:183], v[48:51], v[88:91], v[180:183]
  v_add_u32 v244, s66, v246
  v_mfma_f32_16x16x32_bf16 v[180:183], v[64:67], v[92:95], v[180:183]
  v_add_u32_e64 v245, s66, v247
  v_mfma_f32_16x16x32_bf16 v[188:191], v[68:71], v[92:95], v[188:191]
  v_add_u32_e64 v250, s66, v254
  v_mfma_f32_16x16x32_bf16 v[188:191], v[52:55], v[88:91], v[188:191]
  s_waitcnt lgkmcnt(4)
  v_mfma_f32_16x16x32_bf16 v[192:195], v[52:55], v[72:75], v[192:195]
  ds_read_b64_tr_b16 v[88:89], v249 offset:0
  v_mfma_f32_16x16x32_bf16 v[192:195], v[68:71], v[76:79], v[192:195]
  ds_read_b64_tr_b16 v[90:91], v249 offset:512
  v_mfma_f32_16x16x32_bf16 v[184:187], v[64:67], v[76:79], v[184:187]
  ds_read_b64_tr_b16 v[92:93], v249 offset:4096
  v_mfma_f32_16x16x32_bf16 v[184:187], v[48:51], v[72:75], v[184:187]
  ds_read_b64_tr_b16 v[94:95], v249 offset:4608
  v_mfma_f32_16x16x32_bf16 v[176:179], v[44:47], v[72:75], v[176:179]
  v_add_u32 v248, s66, v252
  v_mfma_f32_16x16x32_bf16 v[176:179], v[60:63], v[76:79], v[176:179]
  v_add_u32_e64 v249, s66, v253
  v_mfma_f32_16x16x32_bf16 v[168:171], v[56:59], v[76:79], v[168:171]
  v_add_u32 v251, s66, v255
  s_add_u32 s67, s67, 2
  v_mfma_f32_16x16x32_bf16 v[168:171], v[40:43], v[72:75], v[168:171]
  s_waitcnt lgkmcnt(4)
  v_mfma_f32_16x16x32_bf16 v[100:103], v[80:83], v[40:43], v[100:103]
  s_waitcnt lgkmcnt(0)
  v_mfma_f32_16x16x32_bf16 v[100:103], v[84:87], v[56:59], v[100:103]
  s_barrier
  v_mfma_f32_16x16x32_bf16 v[108:111], v[84:87], v[60:63], v[108:111]
  ds_read_b128 v[8:11], v244 offset:0
  v_mfma_f32_16x16x32_bf16 v[108:111], v[80:83], v[44:47], v[108:111]
  ds_read_b64_tr_b16 v[72:73], v248 offset:8192
  v_mfma_f32_16x16x32_bf16 v[116:119], v[80:83], v[48:51], v[116:119]
  ds_read_b64_tr_b16 v[74:75], v248 offset:8704
  v_mfma_f32_16x16x32_bf16 v[116:119], v[84:87], v[64:67], v[116:119]
  ds_read_b128 v[24:27], v245 offset:0
  v_mfma_f32_16x16x32_bf16 v[124:127], v[84:87], v[68:71], v[124:127]
  ds_read_b64_tr_b16 v[76:77], v248 offset:12288
  v_mfma_f32_16x16x32_bf16 v[124:127], v[80:83], v[52:55], v[124:127]
  ds_read_b64_tr_b16 v[78:79], v248 offset:12800
  v_mfma_f32_16x16x32_bf16 v[128:131], v[88:91], v[52:55], v[128:131]
  ds_read_b128 v[28:31], v245 offset:2048
  v_mfma_f32_16x16x32_bf16 v[128:131], v[92:95], v[68:71], v[128:131]
  ds_read_b128 v[12:15], v244 offset:2048
  v_mfma_f32_16x16x32_bf16 v[120:123], v[92:95], v[64:67], v[120:123]
  ds_read_b128 v[16:19], v244 offset:4096
  v_mfma_f32_16x16x32_bf16 v[120:123], v[88:91], v[48:51], v[120:123]
  ds_read_b128 v[32:35], v245 offset:4096
  v_mfma_f32_16x16x32_bf16 v[112:115], v[88:91], v[44:47], v[112:115]
  ds_read_b128 v[36:39], v245 offset:6144
  v_mfma_f32_16x16x32_bf16 v[112:115], v[92:95], v[60:63], v[112:115]
  ds_read_b128 v[20:23], v244 offset:6144
  v_mfma_f32_16x16x32_bf16 v[104:107], v[92:95], v[56:59], v[104:107]
  ds_read_b64_tr_b16 v[80:81], v249 offset:8192
  s_waitcnt lgkmcnt(5)
  v_mfma_f32_16x16x32_bf16 v[104:107], v[88:91], v[40:43], v[104:107]
  v_mfma_f32_16x16x32_bf16 v[132:135], v[8:11], v[72:75], v[132:135]
  ds_read_b64_tr_b16 v[82:83], v249 offset:8704
  v_mfma_f32_16x16x32_bf16 v[132:135], v[24:27], v[76:79], v[132:135]
  ds_read_b64_tr_b16 v[84:85], v249 offset:12288
  v_mfma_f32_16x16x32_bf16 v[140:143], v[28:31], v[76:79], v[140:143]
  ds_read_b64_tr_b16 v[86:87], v249 offset:12800
  v_mfma_f32_16x16x32_bf16 v[140:143], v[12:15], v[72:75], v[140:143]
  ds_read_b64_tr_b16 v[88:89], v250 offset:16384
  s_waitcnt lgkmcnt(5)
  v_mfma_f32_16x16x32_bf16 v[148:151], v[16:19], v[72:75], v[148:151]
  ds_read_b64_tr_b16 v[90:91], v250 offset:16896
  v_mfma_f32_16x16x32_bf16 v[148:151], v[32:35], v[76:79], v[148:151]
  ds_read_b64_tr_b16 v[92:93], v250 offset:20480
  v_mfma_f32_16x16x32_bf16 v[156:159], v[36:39], v[76:79], v[156:159]
  ds_read_b64_tr_b16 v[94:95], v250 offset:20992
  v_mfma_f32_16x16x32_bf16 v[156:159], v[20:23], v[72:75], v[156:159]
  s_waitcnt lgkmcnt(4)
  v_mfma_f32_16x16x32_bf16 v[160:163], v[20:23], v[80:83], v[160:163]
  ds_read_b64_tr_b16 v[72:73], v251 offset:16384
  v_mfma_f32_16x16x32_bf16 v[160:163], v[36:39], v[84:87], v[160:163]
  ds_read_b64_tr_b16 v[74:75], v251 offset:16896
  v_mfma_f32_16x16x32_bf16 v[152:155], v[32:35], v[84:87], v[152:155]
  ds_read_b64_tr_b16 v[76:77], v251 offset:20480
  v_mfma_f32_16x16x32_bf16 v[152:155], v[16:19], v[80:83], v[152:155]
  ds_read_b64_tr_b16 v[78:79], v251 offset:20992
  v_mfma_f32_16x16x32_bf16 v[144:147], v[12:15], v[80:83], v[144:147]
  s_add_u32 s66, s66, 40960
  v_mfma_f32_16x16x32_bf16 v[144:147], v[28:31], v[84:87], v[144:147]
  s_cmp_eq_u32 s66, 163840
  v_mfma_f32_16x16x32_bf16 v[136:139], v[24:27], v[84:87], v[136:139]
  s_cselect_b32 s66, 40960, s66
  v_mfma_f32_16x16x32_bf16 v[136:139], v[8:11], v[80:83], v[136:139]
  s_waitcnt lgkmcnt(4)
  v_mfma_f32_16x16x32_bf16 v[164:167], v[8:11], v[88:91], v[164:167]
  ds_read_b64_tr_b16 v[80:81], v248 offset:0
  v_mfma_f32_16x16x32_bf16 v[164:167], v[24:27], v[92:95], v[164:167]
  ds_read_b64_tr_b16 v[82:83], v248 offset:512
  v_mfma_f32_16x16x32_bf16 v[172:175], v[28:31], v[92:95], v[172:175]
  ds_read_b64_tr_b16 v[84:85], v248 offset:4096
  v_mfma_f32_16x16x32_bf16 v[172:175], v[12:15], v[88:91], v[172:175]
  ds_read_b64_tr_b16 v[86:87], v248 offset:4608
  v_mfma_f32_16x16x32_bf16 v[180:183], v[16:19], v[88:91], v[180:183]
  v_add_u32 v244, s66, v246
  v_mfma_f32_16x16x32_bf16 v[180:183], v[32:35], v[92:95], v[180:183]
  v_add_u32_e64 v245, s66, v247
  v_mfma_f32_16x16x32_bf16 v[188:191], v[36:39], v[92:95], v[188:191]
  v_add_u32_e64 v250, s66, v254
  v_mfma_f32_16x16x32_bf16 v[188:191], v[20:23], v[88:91], v[188:191]
  s_waitcnt lgkmcnt(4)
  v_mfma_f32_16x16x32_bf16 v[192:195], v[20:23], v[72:75], v[192:195]
  ds_read_b64_tr_b16 v[88:89], v249 offset:0
  v_mfma_f32_16x16x32_bf16 v[192:195], v[36:39], v[76:79], v[192:195]
  ds_read_b64_tr_b16 v[90:91], v249 offset:512
  v_mfma_f32_16x16x32_bf16 v[184:187], v[32:35], v[76:79], v[184:187]
  ds_read_b64_tr_b16 v[92:93], v249 offset:4096
  v_mfma_f32_16x16x32_bf16 v[184:187], v[16:19], v[72:75], v[184:187]
  ds_read_b64_tr_b16 v[94:95], v249 offset:4608
  v_mfma_f32_16x16x32_bf16 v[176:179], v[12:15], v[72:75], v[176:179]
  v_add_u32 v248, s66, v252
  v_mfma_f32_16x16x32_bf16 v[176:179], v[28:31], v[76:79], v[176:179]
  v_add_u32_e64 v249, s66, v253
  v_mfma_f32_16x16x32_bf16 v[168:171], v[24:27], v[76:79], v[168:171]
  v_add_u32 v251, s66, v255
  s_cmp_lt_u32 s67, 15
  v_mfma_f32_16x16x32_bf16 v[168:171], v[8:11], v[72:75], v[168:171]
  s_waitcnt lgkmcnt(4)
  v_mfma_f32_16x16x32_bf16 v[100:103], v[80:83], v[8:11], v[100:103]
  s_waitcnt lgkmcnt(0)
  v_mfma_f32_16x16x32_bf16 v[100:103], v[84:87], v[24:27], v[100:103]
  s_barrier
  v_mfma_f32_16x16x32_bf16 v[108:111], v[84:87], v[28:31], v[108:111]
  ds_read_b128 v[40:43], v244 offset:0
  v_mfma_f32_16x16x32_bf16 v[108:111], v[80:83], v[12:15], v[108:111]
  ds_read_b64_tr_b16 v[72:73], v248 offset:8192
  v_mfma_f32_16x16x32_bf16 v[116:119], v[80:83], v[16:19], v[116:119]
  ds_read_b64_tr_b16 v[74:75], v248 offset:8704
  v_mfma_f32_16x16x32_bf16 v[116:119], v[84:87], v[32:35], v[116:119]
  ds_read_b128 v[56:59], v245 offset:0
  v_mfma_f32_16x16x32_bf16 v[124:127], v[84:87], v[36:39], v[124:127]
  ds_read_b64_tr_b16 v[76:77], v248 offset:12288
  v_mfma_f32_16x16x32_bf16 v[124:127], v[80:83], v[20:23], v[124:127]
  ds_read_b64_tr_b16 v[78:79], v248 offset:12800
  v_mfma_f32_16x16x32_bf16 v[128:131], v[88:91], v[20:23], v[128:131]
  ds_read_b128 v[60:63], v245 offset:2048
  v_mfma_f32_16x16x32_bf16 v[128:131], v[92:95], v[36:39], v[128:131]
  ds_read_b128 v[44:47], v244 offset:2048
  v_mfma_f32_16x16x32_bf16 v[120:123], v[92:95], v[32:35], v[120:123]
  ds_read_b128 v[48:51], v244 offset:4096
  v_mfma_f32_16x16x32_bf16 v[120:123], v[88:91], v[16:19], v[120:123]
  ds_read_b128 v[64:67], v245 offset:4096
  v_mfma_f32_16x16x32_bf16 v[112:115], v[88:91], v[12:15], v[112:115]
  ds_read_b128 v[68:71], v245 offset:6144
  v_mfma_f32_16x16x32_bf16 v[112:115], v[92:95], v[28:31], v[112:115]
  ds_read_b128 v[52:55], v244 offset:6144
  v_mfma_f32_16x16x32_bf16 v[104:107], v[92:95], v[24:27], v[104:107]
  ds_read_b64_tr_b16 v[80:81], v249 offset:8192
  s_waitcnt lgkmcnt(5)
  v_mfma_f32_16x16x32_bf16 v[104:107], v[88:91], v[8:11], v[104:107]
  s_cbranch_scc1 L_cloop
  v_mfma_f32_16x16x32_bf16 v[132:135], v[40:43], v[72:75], v[132:135]
  ds_read_b64_tr_b16 v[82:83], v249 offset:8704
  v_mfma_f32_16x16x32_bf16 v[132:135], v[56:59], v[76:79], v[132:135]
  ds_read_b64_tr_b16 v[84:85], v249 offset:12288
  v_mfma_f32_16x16x32_bf16 v[140:143], v[60:63], v[76:79], v[140:143]
  ds_read_b64_tr_b16 v[86:87], v249 offset:12800
  v_mfma_f32_16x16x32_bf16 v[140:143], v[44:47], v[72:75], v[140:143]
  ds_read_b64_tr_b16 v[88:89], v250 offset:16384
  s_waitcnt lgkmcnt(8)
  v_mfma_f32_16x16x32_bf16 v[148:151], v[48:51], v[72:75], v[148:151]
  ds_read_b64_tr_b16 v[90:91], v250 offset:16896
  ds_read_b64_tr_b16 v[92:93], v250 offset:20480
  s_waitcnt lgkmcnt(9)
  v_mfma_f32_16x16x32_bf16 v[148:151], v[64:67], v[76:79], v[148:151]
  ds_read_b64_tr_b16 v[94:95], v250 offset:20992
  ds_read_b64_tr_b16 v[8:9], v248 offset:0
  s_waitcnt lgkmcnt(10)
  v_mfma_f32_16x16x32_bf16 v[156:159], v[68:71], v[76:79], v[156:159]
  ds_read_b64_tr_b16 v[10:11], v248 offset:512
  ds_read_b64_tr_b16 v[12:13], v248 offset:4096
  s_waitcnt lgkmcnt(11)
  v_mfma_f32_16x16x32_bf16 v[156:159], v[52:55], v[72:75], v[156:159]
  ds_read_b64_tr_b16 v[14:15], v248 offset:4608
  ds_read_b64_tr_b16 v[16:17], v249 offset:0
  s_waitcnt lgkmcnt(11)
  v_mfma_f32_16x16x32_bf16 v[160:163], v[52:55], v[80:83], v[160:163]
  ds_read_b64_tr_b16 v[72:73], v251 offset:16384
  v_fma_f32 v32, v132, s91, -s91
  s_waitcnt lgkmcnt(10)
  v_mfma_f32_16x16x32_bf16 v[160:163], v[68:71], v[84:87], v[160:163]
  ds_read_b64_tr_b16 v[74:75], v251 offset:16896
  v_fma_f32 v33, v133, s91, -s91
  v_mfma_f32_16x16x32_bf16 v[152:155], v[64:67], v[84:87], v[152:155]
  ds_read_b64_tr_b16 v[76:77], v251 offset:20480
  v_fma_f32 v34, v134, s91, -s91
  v_mfma_f32_16x16x32_bf16 v[152:155], v[48:51], v[80:83], v[152:155]
  ds_read_b64_tr_b16 v[78:79], v251 offset:20992
  v_fma_f32 v35, v135, s91, -s91
  v_mfma_f32_16x16x32_bf16 v[144:147], v[44:47], v[80:83], v[144:147]
  ds_read_b64_tr_b16 v[18:19], v249 offset:512
  v_exp_f32_e64 v32, v32 clamp
  v_mfma_f32_16x16x32_bf16 v[144:147], v[60:63], v[84:87], v[144:147]
  ds_read_b64_tr_b16 v[20:21], v249 offset:4096
  v_exp_f32_e64 v33, v33 clamp
  v_mfma_f32_16x16x32_bf16 v[136:139], v[56:59], v[84:87], v[136:139]
  ds_read_b64_tr_b16 v[22:23], v249 offset:4608
  v_exp_f32_e64 v34, v34 clamp
  v_mfma_f32_16x16x32_bf16 v[136:139], v[40:43], v[80:83], v[136:139]
  v_exp_f32_e64 v35, v35 clamp
  s_waitcnt lgkmcnt(14)
  v_mfma_f32_16x16x32_bf16 v[164:167], v[40:43], v[88:91], v[164:167]
  v_max_f32 v132, v132, v32
  v_max_f32_e64 v133, v133, v33
  s_waitcnt lgkmcnt(12)
  v_mfma_f32_16x16x32_bf16 v[164:167], v[56:59], v[92:95], v[164:167]
  v_max_f32 v134, v134, v34
  v_max_f32 v135, v135, v35
  v_mfma_f32_16x16x32_bf16 v[172:175], v[60:63], v[92:95], v[172:175]
  v_cvt_pk_bf16_f32 v132, v132, v133
  v_cvt_pk_bf16_f32 v133, v134, v135
  v_mfma_f32_16x16x32_bf16 v[172:175], v[44:47], v[88:91], v[172:175]
  v_fma_f32 v32, v140, s91, -s91
  v_fma_f32 v33, v141, s91, -s91
  v_mfma_f32_16x16x32_bf16 v[180:183], v[48:51], v[88:91], v[180:183]
  v_fma_f32 v34, v142, s91, -s91
  v_fma_f32 v35, v143, s91, -s91
  v_mfma_f32_16x16x32_bf16 v[180:183], v[64:67], v[92:95], v[180:183]
  v_exp_f32_e64 v32, v32 clamp
  v_mfma_f32_16x16x32_bf16 v[188:191], v[68:71], v[92:95], v[188:191]
  v_exp_f32_e64 v33, v33 clamp
  v_mfma_f32_16x16x32_bf16 v[188:191], v[52:55], v[88:91], v[188:191]
  v_exp_f32_e64 v34, v34 clamp
  s_waitcnt lgkmcnt(5)
  v_mfma_f32_16x16x32_bf16 v[192:195], v[52:55], v[72:75], v[192:195]
  v_exp_f32_e64 v35, v35 clamp
  s_waitcnt lgkmcnt(3)
  v_mfma_f32_16x16x32_bf16 v[192:195], v[68:71], v[76:79], v[192:195]
  v_max_f32 v140, v140, v32
  v_max_f32 v141, v141, v33
  v_mfma_f32_16x16x32_bf16 v[184:187], v[64:67], v[76:79], v[184:187]
  v_max_f32 v142, v142, v34
  v_max_f32 v143, v143, v35
  v_mfma_f32_16x16x32_bf16 v[184:187], v[48:51], v[72:75], v[184:187]
  v_cvt_pk_bf16_f32 v134, v140, v141
  v_cvt_pk_bf16_f32 v135, v142, v143
  v_mfma_f32_16x16x32_bf16 v[176:179], v[44:47], v[72:75], v[176:179]
  v_fma_f32 v32, v148, s91, -s91
  v_fma_f32 v33, v149, s91, -s91
  v_mfma_f32_16x16x32_bf16 v[176:179], v[60:63], v[76:79], v[176:179]
  v_fma_f32 v34, v150, s91, -s91
  v_fma_f32 v35, v151, s91, -s91
  v_mfma_f32_16x16x32_bf16 v[168:171], v[56:59], v[76:79], v[168:171]
  v_exp_f32_e64 v32, v32 clamp
  v_mfma_f32_16x16x32_bf16 v[168:171], v[40:43], v[72:75], v[168:171]
  v_exp_f32_e64 v33, v33 clamp
  v_exp_f32_e64 v34, v34 clamp
  v_exp_f32_e64 v35, v35 clamp
  v_max_f32 v148, v148, v32
  v_max_f32 v149, v149, v33
  v_max_f32 v150, v150, v34
  v_max_f32 v151, v151, v35
  v_cvt_pk_bf16_f32 v148, v148, v149
  v_cvt_pk_bf16_f32 v149, v150, v151
  v_fma_f32 v32, v156, s91, -s91
  v_fma_f32 v33, v157, s91, -s91
  v_fma_f32 v34, v158, s91, -s91
  v_fma_f32 v35, v159, s91, -s91
  v_exp_f32_e64 v32, v32 clamp
  v_exp_f32_e64 v33, v33 clamp
  v_exp_f32_e64 v34, v34 clamp
  v_exp_f32_e64 v35, v35 clamp
  v_max_f32 v156, v156, v32
  v_max_f32 v157, v157, v33
  v_max_f32 v158, v158, v34
  v_max_f32 v159, v159, v35
  v_cvt_pk_bf16_f32 v150, v156, v157
  v_cvt_pk_bf16_f32 v151, v158, v159
  v_cvt_pk_bf16_f32 v164, v164, v165
  v_cvt_pk_bf16_f32 v165, v166, v167
  v_mfma_f32_16x16x32_bf16 v[24:27], v[200:203], v[132:135], 0
  v_cvt_pk_bf16_f32 v166, v172, v173
  v_cvt_pk_bf16_f32 v167, v174, v175
  v_mfma_f32_16x16x32_bf16 v[24:27], v[200:203], v[148:151], v[24:27]
  v_cvt_pk_bf16_f32 v180, v180, v181
  v_cvt_pk_bf16_f32 v181, v182, v183
  v_cvt_pk_bf16_f32 v182, v188, v189
  v_cvt_pk_bf16_f32 v183, v190, v191
  v_cvt_pk_bf16_f32 v168, v168, v169
  v_cvt_pk_bf16_f32 v169, v170, v171
  v_mfma_f32_16x16x32_bf16 v[80:83], v[220:223], v[164:167], 0
  v_cvt_pk_bf16_f32 v170, v176, v177
  v_cvt_pk_bf16_f32 v171, v178, v179
  v_mfma_f32_16x16x32_bf16 v[80:83], v[220:223], v[180:183], v[80:83]
  v_cvt_pk_bf16_f32 v184, v184, v185
  v_cvt_pk_bf16_f32 v185, v186, v187
  v_cvt_pk_bf16_f32 v186, v192, v193
  v_cvt_pk_bf16_f32 v187, v194, v195
  v_fma_f32 v32, v136, s91, -s91
  v_fma_f32 v33, v137, s91, -s91
  v_mfma_f32_16x16x32_bf16 v[84:87], v[220:223], v[168:171], 0
  v_fma_f32 v34, v138, s91, -s91
  v_fma_f32 v35, v139, s91, -s91
  v_mfma_f32_16x16x32_bf16 v[84:87], v[220:223], v[184:187], v[84:87]
  v_exp_f32_e64 v32, v32 clamp
L_pad_4:
  s_cmp_eq_u32 s101, 1
  s_cbranch_scc1 L_res_c
  v_mfma_f32_16x16x32_bf16 v[240:243], v[132:135], v[164:167], v[80:83]
  v_exp_f32_e64 v33, v33 clamp
  v_mfma_f32_16x16x32_bf16 v[240:243], v[148:151], v[180:183], v[240:243]
  v_exp_f32_e64 v34, v34 clamp
  v_mfma_f32_16x16x32_bf16 v[248:251], v[132:135], v[168:171], v[84:87]
  v_exp_f32_e64 v35, v35 clamp
  v_mfma_f32_16x16x32_bf16 v[248:251], v[148:151], v[184:187], v[248:251]
  v_max_f32 v136, v136, v32
  v_max_f32 v137, v137, v33
  v_max_f32 v138, v138, v34
  v_max_f32 v139, v139, v35
  v_cvt_pk_bf16_f32 v136, v136, v137
  v_cvt_pk_bf16_f32 v137, v138, v139
  v_fma_f32 v32, v144, s91, -s91
  v_fma_f32 v33, v145, s91, -s91
  v_fma_f32 v34, v146, s91, -s91
  v_fma_f32 v35, v147, s91, -s91
  v_exp_f32_e64 v32, v32 clamp
  v_exp_f32_e64 v33, v33 clamp
  v_exp_f32_e64 v34, v34 clamp
  v_exp_f32_e64 v35, v35 clamp
  v_max_f32 v144, v144, v32
  v_max_f32 v145, v145, v33
  v_max_f32 v146, v146, v34
  v_max_f32 v147, v147, v35
  v_cvt_pk_bf16_f32 v138, v144, v145
  v_cvt_pk_bf16_f32 v139, v146, v147
  v_fma_f32 v32, v152, s91, -s91
  v_fma_f32 v33, v153, s91, -s91
  v_mfma_f32_16x16x32_bf16 v[252:255], v[136:139], v[168:171], v[84:87]
  v_fma_f32 v34, v154, s91, -s91
  v_fma_f32 v35, v155, s91, -s91
  v_mfma_f32_16x16x32_bf16 v[28:31], v[200:203], v[136:139], 0
  v_exp_f32_e64 v32, v32 clamp
  v_mfma_f32_16x16x32_bf16 v[244:247], v[136:139], v[164:167], v[80:83]
  v_exp_f32_e64 v33, v33 clamp
  v_exp_f32_e64 v34, v34 clamp
  v_exp_f32_e64 v35, v35 clamp
  v_max_f32 v152, v152, v32
  v_max_f32 v153, v153, v33
  v_max_f32 v154, v154, v34
  v_max_f32 v155, v155, v35
  v_cvt_pk_bf16_f32 v152, v152, v153
  v_cvt_pk_bf16_f32 v153, v154, v155
  ds_write_b128 v198, v[248:251] offset:0
  s_mov_b64 exec, 1
  ds_add_rtn_u32 v229, v206, v97 offset:56
  s_mov_b64 exec, -1
  v_fma_f32 v32, v160, s91, -s91
  v_fma_f32 v33, v161, s91, -s91
  v_fma_f32 v34, v162, s91, -s91
  v_fma_f32 v35, v163, s91, -s91
  v_exp_f32_e64 v32, v32 clamp
  v_exp_f32_e64 v33, v33 clamp
  v_exp_f32_e64 v34, v34 clamp
  v_exp_f32_e64 v35, v35 clamp
  v_max_f32 v160, v160, v32
  v_max_f32 v161, v161, v33
  v_max_f32 v162, v162, v34
  v_max_f32 v163, v163, v35
  v_cvt_pk_bf16_f32 v154, v160, v161
  v_cvt_pk_bf16_f32 v155, v162, v163
  v_mfma_f32_16x16x32_bf16 v[100:103], v[8:11], v[40:43], v[100:103]
  s_nop 0
  v_mfma_f32_16x16x32_bf16 v[252:255], v[152:155], v[184:187], v[252:255]
  v_mfma_f32_16x16x32_bf16 v[28:31], v[200:203], v[152:155], v[28:31]
  v_mfma_f32_16x16x32_bf16 v[244:247], v[152:155], v[180:183], v[244:247]
  v_mfma_f32_16x16x32_bf16 v[100:103], v[12:15], v[56:59], v[100:103]
  v_mfma_f32_16x16x32_bf16 v[108:111], v[12:15], v[60:63], v[108:111]
  s_waitcnt lgkmcnt(0)
  v_readfirstlane_b32 s70, v229
  s_nop 0
  s_cmp_lg_u32 s70, 3
  s_cbranch_scc1 L_sig_13
  buffer_atomic_add v228, v196, s[48:51], s95 offen sc0 sc1
L_sig_13:
  ds_write_b128 v198, v[252:255] offset:1024
  v_cndmask_b32 v5, v28, v24, vcc
  v_cndmask_b32 v6, v24, v28, vcc
  ds_write_b32 v98, v5 offset:35072
  ds_write_b32 v199, v97 offset:0
  ds_read_b32 v3, v96 offset:0
  ds_read_b128 v[72:75], v207 offset:0
  ds_read_b128 v[76:79], v207 offset:1024
  ds_read_b32 v5, v99 offset:35072
  v_mfma_f32_16x16x32_bf16 v[108:111], v[8:11], v[44:47], v[108:111]
  v_mfma_f32_16x16x32_bf16 v[116:119], v[8:11], v[48:51], v[116:119]
  v_mfma_f32_16x16x32_bf16 v[116:119], v[12:15], v[64:67], v[116:119]
  v_mfma_f32_16x16x32_bf16 v[124:127], v[12:15], v[68:71], v[124:127]
  v_mfma_f32_16x16x32_bf16 v[124:127], v[8:11], v[52:55], v[124:127]
  s_waitcnt lgkmcnt(3)
  v_cmp_ne_u32 vcc, 1, v3
  s_nop 0
  s_cbranch_vccz L_lpoll_14r
L_lpoll_14:
  ds_read_b32 v3, v96 offset:0
  ds_read_b128 v[72:75], v207 offset:0
  ds_read_b128 v[76:79], v207 offset:1024
  ds_read_b32 v5, v99 offset:35072
  s_waitcnt lgkmcnt(3)
  v_cmp_ne_u32_e64 vcc, 1, v3
  s_nop 0
  s_cbranch_vccnz L_lpoll_14
L_lpoll_14r:
  s_waitcnt lgkmcnt(0)
  v_cvt_pk_bf16_f32 v5, v5, v6
  v_min_u32_e64 v5, -2, v5
  buffer_store_dword v5, v204, s[48:51], s39 offen sc1
  v_add_f32 v72, v72, v240
  v_add_f32 v73, v73, v241
  v_add_f32 v74, v74, v242
  v_add_f32 v75, v75, v243
  v_add_f32 v76, v76, v244
  v_add_f32 v77, v77, v245
  v_add_f32 v78, v78, v246
  v_add_f32 v79, v79, v247
  v_cvt_pk_bf16_f32 v36, v72, v73
  v_cvt_pk_bf16_f32 v37, v74, v75
  v_cvt_pk_bf16_f32 v38, v76, v77
  v_cvt_pk_bf16_f32 v39, v78, v79
  v_min_u32 v36, -2, v36
  v_min_u32 v37, -2, v37
  v_min_u32 v38, -2, v38
  v_min_u32 v39, -2, v39
  buffer_store_dwordx4 v[36:39], v197, s[48:51], s38 offen sc1
  v_mfma_f32_16x16x32_bf16 v[128:131], v[16:19], v[52:55], v[128:131]
  v_fma_f32 v76, v100, s91, -s91
  v_fma_f32 v77, v101, s91, -s91
  v_mfma_f32_16x16x32_bf16 v[128:131], v[20:23], v[68:71], v[128:131]
  v_fma_f32 v78, v102, s91, -s91
  v_fma_f32 v79, v103, s91, -s91
  v_mfma_f32_16x16x32_bf16 v[120:123], v[20:23], v[64:67], v[120:123]
  v_exp_f32_e64 v76, v76 clamp
  v_mfma_f32_16x16x32_bf16 v[120:123], v[16:19], v[48:51], v[120:123]
  v_exp_f32_e64 v77, v77 clamp
  v_mfma_f32_16x16x32_bf16 v[112:115], v[16:19], v[44:47], v[112:115]
  v_exp_f32_e64 v78, v78 clamp
  v_mfma_f32_16x16x32_bf16 v[112:115], v[20:23], v[60:63], v[112:115]
  v_exp_f32_e64 v79, v79 clamp
  v_mfma_f32_16x16x32_bf16 v[104:107], v[20:23], v[56:59], v[104:107]
  v_max_f32 v100, v100, v76
  v_max_f32 v101, v101, v77
  v_mfma_f32_16x16x32_bf16 v[104:107], v[16:19], v[40:43], v[104:107]
  v_max_f32 v102, v102, v78
  v_max_f32 v103, v103, v79
  v_cvt_pk_bf16_f32 v24, v100, v101
  v_cvt_pk_bf16_f32 v25, v102, v103
  v_mov_b32_e64 v234, 0
  s_cmp_lg_u32 s70, 3
  s_cbranch_scc1 L_pre_15
  buffer_atomic_add v234, v205, s[48:51], s89 offen sc0 sc1
L_pre_15:
  v_fma_f32 v76, v108, s91, -s91
  v_fma_f32 v77, v109, s91, -s91
  v_fma_f32 v78, v110, s91, -s91
  v_fma_f32 v79, v111, s91, -s91
  v_exp_f32_e64 v76, v76 clamp
  v_exp_f32_e64 v77, v77 clamp
  v_exp_f32_e64 v78, v78 clamp
  v_exp_f32_e64 v79, v79 clamp
  v_max_f32 v108, v108, v76
  v_max_f32 v109, v109, v77
  v_max_f32 v110, v110, v78
  v_max_f32 v111, v111, v79
  v_cvt_pk_bf16_f32 v28, v108, v109
  v_cvt_pk_bf16_f32 v29, v110, v111
  v_fma_f32 v76, v116, s91, -s91
  v_fma_f32 v77, v117, s91, -s91
  v_fma_f32 v78, v118, s91, -s91
  v_fma_f32 v79, v119, s91, -s91
  v_exp_f32_e64 v76, v76 clamp
  v_exp_f32_e64 v77, v77 clamp
  v_exp_f32_e64 v78, v78 clamp
  v_exp_f32_e64 v79, v79 clamp
  v_max_f32 v116, v116, v76
  v_max_f32 v117, v117, v77
  v_max_f32 v118, v118, v78
  v_max_f32 v119, v119, v79
  v_cvt_pk_bf16_f32 v32, v116, v117
  v_cvt_pk_bf16_f32 v33, v118, v119
  v_fma_f32 v76, v124, s91, -s91
  v_fma_f32 v77, v125, s91, -s91
  v_fma_f32 v78, v126, s91, -s91
  v_fma_f32 v79, v127, s91, -s91
  v_exp_f32_e64 v76, v76 clamp
  v_exp_f32_e64 v77, v77 clamp
  v_exp_f32_e64 v78, v78 clamp
  v_exp_f32_e64 v79, v79 clamp
  v_max_f32 v124, v124, v76
  v_max_f32 v125, v125, v77
  v_max_f32 v126, v126, v78
  v_max_f32 v127, v127, v79
  v_cvt_pk_bf16_f32 v36, v124, v125
  v_cvt_pk_bf16_f32 v37, v126, v127
  v_fma_f32 v76, v128, s91, -s91
  v_fma_f32 v77, v129, s91, -s91
  v_fma_f32 v78, v130, s91, -s91
  v_fma_f32 v79, v131, s91, -s91
  v_exp_f32_e64 v76, v76 clamp
  v_exp_f32_e64 v77, v77 clamp
  v_exp_f32_e64 v78, v78 clamp
  v_exp_f32_e64 v79, v79 clamp
  v_max_f32 v128, v128, v76
  v_max_f32 v129, v129, v77
  v_max_f32 v130, v130, v78
  v_max_f32 v131, v131, v79
  v_cvt_pk_bf16_f32 v38, v128, v129
  v_cvt_pk_bf16_f32 v39, v130, v131
  v_mov_b32_e64 v235, 0
  s_cmp_lg_u32 s70, 3
  s_cbranch_scc1 L_pre_16
  buffer_atomic_add v235, v205, s[48:51], s89 offen sc0 sc1
L_pre_16:
  v_fma_f32 v76, v120, s91, -s91
  v_fma_f32 v77, v121, s91, -s91
  v_fma_f32 v78, v122, s91, -s91
  v_fma_f32 v79, v123, s91, -s91
  v_exp_f32_e64 v76, v76 clamp
  v_exp_f32_e64 v77, v77 clamp
  v_exp_f32_e64 v78, v78 clamp
  v_exp_f32_e64 v79, v79 clamp
  v_max_f32 v120, v120, v76
  v_max_f32 v121, v121, v77
  v_max_f32 v122, v122, v78
  v_max_f32 v123, v123, v79
  v_cvt_pk_bf16_f32 v34, v120, v121
  v_cvt_pk_bf16_f32 v35, v122, v123
  v_fma_f32 v76, v112, s91, -s91
  v_fma_f32 v77, v113, s91, -s91
  v_fma_f32 v78, v114, s91, -s91
  v_fma_f32 v79, v115, s91, -s91
  v_exp_f32_e64 v76, v76 clamp
  v_exp_f32_e64 v77, v77 clamp
  v_exp_f32_e64 v78, v78 clamp
  v_exp_f32_e64 v79, v79 clamp
  v_max_f32 v112, v112, v76
  v_max_f32 v113, v113, v77
  v_max_f32 v114, v114, v78
  v_max_f32 v115, v115, v79
  v_cvt_pk_bf16_f32 v30, v112, v113
  v_cvt_pk_bf16_f32 v31, v114, v115
  v_fma_f32 v76, v104, s91, -s91
  v_fma_f32 v77, v105, s91, -s91
  v_fma_f32 v78, v106, s91, -s91
  v_fma_f32 v79, v107, s91, -s91
  v_exp_f32_e64 v76, v76 clamp
  v_exp_f32_e64 v77, v77 clamp
  v_exp_f32_e64 v78, v78 clamp
  v_exp_f32_e64 v79, v79 clamp
  v_max_f32 v104, v104, v76
  v_max_f32 v105, v105, v77
  v_max_f32 v106, v106, v78
  v_max_f32 v107, v107, v79
  v_cvt_pk_bf16_f32 v26, v104, v105
  v_cvt_pk_bf16_f32 v27, v106, v107
  s_cmp_lg_u32 s70, 3
  s_cbranch_scc1 L_pollo_19
  s_mov_b32 s97, 200000
  s_waitcnt vmcnt(2)
  v_cmp_eq_u32 vcc, 15, v228
  s_nop 0
  s_cbranch_vccnz L_polld_18
  v_mov_b32_e64 v238, 0
  buffer_atomic_add v238, v205, s[48:51], s89 offen sc0 sc1
L_poll_17:
  s_waitcnt vmcnt(2)
  v_readfirstlane_b32 s71, v234
  s_nop 0
  s_cmp_ge_u32 s71, 16
  s_cbranch_scc1 L_polld_18
  v_mov_b32 v234, 0
  buffer_atomic_add v234, v205, s[48:51], s89 offen sc0 sc1
  s_waitcnt vmcnt(2)
  v_readfirstlane_b32 s71, v235
  s_nop 0
  s_cmp_ge_u32 s71, 16
  s_cbranch_scc1 L_polld_18
  v_mov_b32 v235, 0
  buffer_atomic_add v235, v205, s[48:51], s89 offen sc0 sc1
  s_waitcnt vmcnt(2)
  v_readfirstlane_b32 s71, v238
  s_nop 0
  s_cmp_ge_u32 s71, 16
  s_cbranch_scc1 L_polld_18
  v_mov_b32 v238, 0
  buffer_atomic_add v238, v205, s[48:51], s89 offen sc0 sc1
  s_sub_u32 s97, s97, 1
  s_cbranch_scc0 L_poll_17
L_polld_18:
  ds_write_b32 v206, v97 offset:60
  s_branch L_polle_20
L_pollo_19:
L_lpoll_21:
  ds_read_b32 v238, v206 offset:60
  s_waitcnt lgkmcnt(0)
  v_cmp_ne_u32_e64 vcc, 1, v238
  s_nop 0
  s_cbranch_vccnz L_lpoll_21
L_polle_20:
  buffer_load_dwordx4 v[40:43], v197, s[48:51], s94 offen offset:0 sc1
  buffer_load_dwordx4 v[44:47], v197, s[48:51], s94 offen offset:1024 sc1
  buffer_load_dwordx4 v[132:135], v197, s[48:51], s96 offen offset:0 sc1
  buffer_load_dwordx4 v[136:139], v197, s[48:51], s96 offen offset:1024 sc1
  buffer_load_dwordx4 v[140:143], v197, s[48:51], s96 offen offset:2048 sc1
  buffer_load_dwordx4 v[144:147], v197, s[48:51], s96 offen offset:3072 sc1
  s_xor_b32 s96, s96, 4096
  buffer_load_dwordx4 v[148:151], v197, s[48:51], s96 offen offset:0 sc1
  buffer_load_dwordx4 v[152:155], v197, s[48:51], s96 offen offset:1024 sc1
  buffer_load_dwordx4 v[156:159], v197, s[48:51], s96 offen offset:2048 sc1
  s_mul_i32 s95, s4, 8448
  s_add_u32 s95, s95, 659456
  s_mov_b32 s97, 200000
L_zchk:
  s_waitcnt vmcnt(8)
  v_max3_u32 v12, v40, v41, v42
  s_waitcnt vmcnt(7)
  v_max3_u32 v12, v12, v43, v44
  v_max3_u32 v12, v12, v45, v46
  v_max_u32 v12, v12, v47
  v_cmp_eq_u32 vcc, -1, v12
  s_nop 0
  s_cbranch_vccnz L_zretry
L_zok:
  v_mfma_f32_16x16x32_bf16 v[48:51], v[40:43], v[200:203], v[224:227]
  v_mfma_f32_16x16x32_bf16 v[52:55], v[44:47], v[200:203], v[224:227]
  s_waitcnt vmcnt(6)
  v_mfma_f32_16x16x32_bf16 v[56:59], v[210:213], v[132:135], 0
  v_mfma_f32_16x16x32_bf16 v[60:63], v[208:211], v[132:135], 0
  buffer_load_dwordx4 v[160:163], v197, s[48:51], s96 offen offset:3072 sc1
  v_max3_u32 v12, v12, v132, v133
  v_max3_u32 v12, v12, v134, v135
  s_waitcnt vmcnt(6)
  v_mfma_f32_16x16x32_bf16 v[56:59], v[210:213], v[136:139], v[56:59]
  v_mfma_f32_16x16x32_bf16 v[60:63], v[208:211], v[136:139], v[60:63]
  s_xor_b32 s96, s96, 12288
  buffer_load_dwordx4 v[164:167], v197, s[48:51], s96 offen offset:0 sc1
  v_max3_u32 v12, v12, v136, v137
  v_max3_u32 v12, v12, v138, v139
  v_cvt_pk_bf16_f32 v8, v48, v49
  v_cvt_pk_bf16_f32 v9, v50, v51
  v_cvt_pk_bf16_f32 v10, v52, v53
  v_cvt_pk_bf16_f32 v11, v54, v55
  s_waitcnt vmcnt(6)
  v_mfma_f32_16x16x32_bf16 v[56:59], v[210:213], v[140:143], v[56:59]
  v_mfma_f32_16x16x32_bf16 v[216:219], v[8:11], v[220:223], v[216:219]
  v_mfma_f32_16x16x32_bf16 v[60:63], v[208:211], v[140:143], v[60:63]
  buffer_load_dwordx4 v[168:171], v197, s[48:51], s96 offen offset:1024 sc1
  v_max3_u32 v12, v12, v140, v141
  v_max3_u32 v12, v12, v142, v143
  s_waitcnt vmcnt(6)
  v_mfma_f32_16x16x32_bf16 v[56:59], v[210:213], v[144:147], v[56:59]
  v_mfma_f32_16x16x32_bf16 v[60:63], v[208:211], v[144:147], v[60:63]
  buffer_load_dwordx4 v[172:175], v197, s[48:51], s96 offen offset:2048 sc1
  v_max3_u32 v12, v12, v144, v145
  v_max3_u32 v12, v12, v146, v147
  v_mfma_f32_16x16x32_bf16 v[72:75], v[8:11], v[24:27], v[216:219]
  v_mfma_f32_16x16x32_bf16 v[76:79], v[8:11], v[28:31], v[216:219]
  v_mfma_f32_16x16x32_bf16 v[80:83], v[8:11], v[32:35], v[216:219]
  v_mfma_f32_16x16x32_bf16 v[84:87], v[8:11], v[36:39], v[216:219]
  s_waitcnt vmcnt(6)
  v_mfma_f32_16x16x32_bf16 v[56:59], v[210:213], v[148:151], v[56:59]
  v_mfma_f32_16x16x32_bf16 v[60:63], v[208:211], v[148:151], v[60:63]
  buffer_load_dwordx4 v[176:179], v197, s[48:51], s96 offen offset:3072 sc1
  v_max3_u32 v12, v12, v148, v149
  v_max3_u32 v12, v12, v150, v151
  s_waitcnt vmcnt(6)
  v_mfma_f32_16x16x32_bf16 v[56:59], v[210:213], v[152:155], v[56:59]
  v_rcp_f32 v72, v72
  v_rcp_f32 v76, v76
  v_mfma_f32_16x16x32_bf16 v[60:63], v[208:211], v[152:155], v[60:63]
  s_xor_b32 s96, s96, 4096
  buffer_load_dwordx4 v[180:183], v197, s[48:51], s96 offen offset:0 sc1
  v_max3_u32 v12, v12, v152, v153
  v_max3_u32 v12, v12, v154, v155
  v_rcp_f32 v80, v80
  v_rcp_f32_e64 v84, v84
  s_waitcnt vmcnt(6)
  v_mfma_f32_16x16x32_bf16 v[56:59], v[210:213], v[156:159], v[56:59]
  v_mul_f32 v73, s90, v72
  v_mul_f32 v77, s90, v76
  v_mul_f32_e64 v81, s90, v80
  v_mfma_f32_16x16x32_bf16 v[60:63], v[208:211], v[156:159], v[60:63]
  buffer_load_dwordx4 v[184:187], v197, s[48:51], s96 offen offset:1024 sc1
  v_max3_u32 v12, v12, v156, v157
  v_max3_u32 v12, v12, v158, v159
  v_mul_f32_e64 v85, s90, v84
  v_fma_f32 v100, v100, v72, v73
  v_fma_f32 v101, v101, v72, v73
  s_waitcnt vmcnt(6)
  v_mfma_f32_16x16x32_bf16 v[56:59], v[210:213], v[160:163], v[56:59]
  v_fma_f32 v102, v102, v72, v73
  v_fma_f32 v103, v103, v72, v73
  v_fma_f32 v104, v104, v72, v73
  v_mfma_f32_16x16x32_bf16 v[60:63], v[208:211], v[160:163], v[60:63]
  buffer_load_dwordx4 v[188:191], v197, s[48:51], s96 offen offset:2048 sc1
  v_max3_u32 v12, v12, v160, v161
  v_max3_u32 v12, v12, v162, v163
  v_fma_f32 v105, v105, v72, v73
  v_fma_f32 v106, v106, v72, v73
  v_fma_f32 v107, v107, v72, v73
  s_waitcnt vmcnt(6)
  v_mfma_f32_16x16x32_bf16 v[56:59], v[210:213], v[164:167], v[56:59]
  v_cvt_pk_bf16_f32 v24, v100, v101
  v_cvt_pk_bf16_f32 v25, v102, v103
  v_cvt_pk_bf16_f32 v26, v104, v105
  v_mfma_f32_16x16x32_bf16 v[60:63], v[208:211], v[164:167], v[60:63]
  buffer_load_dwordx4 v[192:195], v197, s[48:51], s96 offen offset:3072 sc1
  v_max3_u32 v12, v12, v164, v165
  v_max3_u32 v12, v12, v166, v167
  v_cvt_pk_bf16_f32 v27, v106, v107
  v_fma_f32 v108, v108, v76, v77
  v_fma_f32 v109, v109, v76, v77
  s_waitcnt vmcnt(6)
  v_mfma_f32_16x16x32_bf16 v[56:59], v[210:213], v[168:171], v[56:59]
  v_fma_f32 v110, v110, v76, v77
  v_fma_f32 v111, v111, v76, v77
  v_fma_f32 v112, v112, v76, v77
  v_mfma_f32_16x16x32_bf16 v[60:63], v[208:211], v[168:171], v[60:63]
  v_max3_u32 v12, v12, v168, v169
  v_max3_u32 v12, v12, v170, v171
  v_fma_f32 v113, v113, v76, v77
  v_fma_f32 v114, v114, v76, v77
  v_fma_f32 v115, v115, v76, v77
  s_waitcnt vmcnt(5)
  v_mfma_f32_16x16x32_bf16 v[56:59], v[210:213], v[172:175], v[56:59]
  v_cvt_pk_bf16_f32 v28, v108, v109
  v_cvt_pk_bf16_f32 v29, v110, v111
  v_cvt_pk_bf16_f32 v30, v112, v113
  v_mfma_f32_16x16x32_bf16 v[60:63], v[208:211], v[172:175], v[60:63]
  v_max3_u32 v12, v12, v172, v173
  v_max3_u32 v12, v12, v174, v175
  v_cvt_pk_bf16_f32 v31, v114, v115
  v_fma_f32 v116, v116, v80, v81
  v_fma_f32 v117, v117, v80, v81
  s_waitcnt vmcnt(4)
  v_mfma_f32_16x16x32_bf16 v[56:59], v[210:213], v[176:179], v[56:59]
  v_fma_f32 v118, v118, v80, v81
  v_fma_f32 v119, v119, v80, v81
  v_fma_f32 v120, v120, v80, v81
  v_mfma_f32_16x16x32_bf16 v[60:63], v[208:211], v[176:179], v[60:63]
  v_max3_u32 v12, v12, v176, v177
  v_max3_u32 v12, v12, v178, v179
  v_fma_f32 v121, v121, v80, v81
  v_fma_f32 v122, v122, v80, v81
  v_fma_f32 v123, v123, v80, v81
  s_waitcnt vmcnt(3)
  v_mfma_f32_16x16x32_bf16 v[56:59], v[210:213], v[180:183], v[56:59]
  v_cvt_pk_bf16_f32 v32, v116, v117
  v_cvt_pk_bf16_f32 v33, v118, v119
  v_cvt_pk_bf16_f32 v34, v120, v121
  v_mfma_f32_16x16x32_bf16 v[60:63], v[208:211], v[180:183], v[60:63]
  v_max3_u32 v12, v12, v180, v181
  v_max3_u32 v12, v12, v182, v183
  v_cvt_pk_bf16_f32 v35, v122, v123
  v_fma_f32 v124, v124, v84, v85
  v_fma_f32 v125, v125, v84, v85
  s_waitcnt vmcnt(2)
  v_mfma_f32_16x16x32_bf16 v[56:59], v[210:213], v[184:187], v[56:59]
  v_fma_f32 v126, v126, v84, v85
  v_fma_f32 v127, v127, v84, v85
  v_fma_f32 v128, v128, v84, v85
  v_mfma_f32_16x16x32_bf16 v[60:63], v[208:211], v[184:187], v[60:63]
  v_max3_u32 v12, v12, v184, v185
  v_max3_u32 v12, v12, v186, v187
  v_fma_f32 v129, v129, v84, v85
  v_fma_f32 v130, v130, v84, v85
  v_fma_f32 v131, v131, v84, v85
  s_waitcnt vmcnt(1)
  v_mfma_f32_16x16x32_bf16 v[56:59], v[210:213], v[188:191], v[56:59]
  v_cvt_pk_bf16_f32 v36, v124, v125
  v_cvt_pk_bf16_f32 v37, v126, v127
  v_cvt_pk_bf16_f32 v38, v128, v129
  v_mfma_f32_16x16x32_bf16 v[60:63], v[208:211], v[188:191], v[60:63]
  v_max3_u32 v12, v12, v188, v189
  v_max3_u32 v12, v12, v190, v191
  v_cvt_pk_bf16_f32 v39, v130, v131
  s_waitcnt vmcnt(0)
  v_mfma_f32_16x16x32_bf16 v[56:59], v[210:213], v[192:195], v[56:59]
  v_mfma_f32_16x16x32_bf16 v[60:63], v[208:211], v[192:195], v[60:63]
  v_max3_u32 v12, v12, v192, v193
  v_max3_u32 v12, v12, v194, v195
L_kchk:
  v_cmp_eq_u32_e64 vcc, -1, v12
  s_nop 0
  s_cbranch_vccnz L_kretry
L_kok:
  s_nop 1
  v_cvt_pk_bf16_f32 v20, v56, v57
  v_cvt_pk_bf16_f32 v21, v58, v59
  v_cvt_pk_bf16_f32 v22, v60, v61
  v_cvt_pk_bf16_f32 v23, v62, v63
  ds_write_b128 v198, v[20:23] offset:0
  ds_write_b32 v199, v97 offset:16
  ds_read_b32 v3, v96 offset:16
  ds_read_b128 v[64:67], v207 offset:0
  v_mfma_f32_16x16x32_bf16 v[100:103], v[20:23], v[24:27], 0
  v_mfma_f32_16x16x32_bf16 v[108:111], v[20:23], v[28:31], 0
  v_mfma_f32_16x16x32_bf16 v[116:119], v[20:23], v[32:35], 0
  v_mfma_f32_16x16x32_bf16 v[124:127], v[20:23], v[36:39], 0
  s_waitcnt lgkmcnt(1)
  v_cmp_ne_u32 vcc, 1, v3
  s_nop 0
  s_cbranch_vccz L_lpoll_22r
L_lpoll_22:
  ds_read_b32 v3, v96 offset:16
  ds_read_b128 v[64:67], v207 offset:0
  s_waitcnt lgkmcnt(1)
  v_cmp_ne_u32_e64 vcc, 1, v3
  s_nop 0
  s_cbranch_vccnz L_lpoll_22
L_lpoll_22r:
  s_waitcnt lgkmcnt(0)
  v_mfma_f32_16x16x32_bf16 v[104:107], v[64:67], v[24:27], 0
  v_cvt_pk_bf16_f32 v132, v100, v101
  v_cvt_pk_bf16_f32 v133, v102, v103
  v_mfma_f32_16x16x32_bf16 v[112:115], v[64:67], v[28:31], 0
  v_cvt_pk_bf16_f32 v136, v108, v109
  v_cvt_pk_bf16_f32 v137, v110, v111
  v_mfma_f32_16x16x32_bf16 v[120:123], v[64:67], v[32:35], 0
  v_cvt_pk_bf16_f32 v140, v116, v117
  v_cvt_pk_bf16_f32 v141, v118, v119
  v_mfma_f32_16x16x32_bf16 v[128:131], v[64:67], v[36:39], 0
  v_cvt_pk_bf16_f32 v144, v124, v125
  v_cvt_pk_bf16_f32 v145, v126, v127
  v_cvt_pk_bf16_f32 v134, v104, v105
  v_cvt_pk_bf16_f32 v135, v106, v107
  buffer_store_dwordx4 v[132:135], v197, s[48:51], s93 offen sc1
  s_add_u32 s93, s93, 32768
  v_cvt_pk_bf16_f32 v138, v112, v113
  v_cvt_pk_bf16_f32 v139, v114, v115
  buffer_store_dwordx4 v[136:139], v197, s[48:51], s93 offen sc1
  s_add_u32 s93, s93, 32768
  v_cvt_pk_bf16_f32 v142, v120, v121
  v_cvt_pk_bf16_f32 v143, v122, v123
  buffer_store_dwordx4 v[140:143], v197, s[48:51], s93 offen sc1
  s_add_u32 s93, s93, 32768
  v_cvt_pk_bf16_f32 v146, v128, v129
  v_cvt_pk_bf16_f32 v147, v130, v131
  buffer_store_dwordx4 v[144:147], v197, s[48:51], s93 offen sc1
  v_lshrrev_b32_e64 v3, 2, v2
  v_bfe_u32 v5, v2, 3, 2
  v_lshlrev_b32_e64 v5, 5, v5
  v_lshl_add_u32 v5, v3, 7, v5
  s_lshl_b32 s88, s65, 11
  v_and_b32 v3, 3, v2
  v_lshlrev_b32_e64 v3, 3, v3
  v_add3_u32 v100, v3, v5, s88
  v_add_u32 v104, 61440, v100
  v_add_u32 v108, 122880, v100
  v_xor_b32_e64 v101, 32, v100
  v_add_u32 v105, 61440, v101
  v_add_u32 v109, 122880, v101
  v_xor_b32_e64 v102, 64, v100
  v_add_u32 v106, 61440, v102
  v_add_u32 v110, 122880, v102
  v_xor_b32 v103, 96, v100
  v_add_u32 v107, 61440, v103
  v_add_u32 v111, 122880, v103
  v_xor_b32 v112, 2048, v100
  v_add_u32 v116, 61440, v112
  v_add_u32 v120, 122880, v112
  v_xor_b32 v113, 2080, v100
  v_add_u32 v117, 61440, v113
  v_add_u32 v121, 122880, v113
  v_xor_b32 v114, 2112, v100
  v_add_u32 v118, 61440, v114
  v_add_u32 v122, 122880, v114
  v_xor_b32 v115, 2144, v100
  v_add_u32 v119, 61440, v115
  v_add_u32 v123, 122880, v115
  s_lshl2_add_u32 s88, s6, s3
  s_lshl_b32 s38, s88, 16
  s_add_u32 s38, s38, 12582912
  s_add_u32 s39, s38, 32768
  s_mul_i32 s96, s6, 8448
  s_add_u32 s96, s96, 659456
  s_mov_b32 s89, s7
  s_and_b32 s89, s89, 3
  s_mul_i32 s89, s89, 2304
  s_add_u32 s96, s96, s89
  s_waitcnt vmcnt(0)
  s_mov_b64 exec, 1
  ds_add_rtn_u32 v3, v206, v97 offset:64
  s_mov_b64 exec, -1
  s_waitcnt lgkmcnt(0)
  v_readfirstlane_b32 s70, v3
  s_nop 0
  s_cmp_lg_u32 s70, 3
  s_cbranch_scc1 L_arr_23
  buffer_atomic_add v97, v196, s[48:51], s95 offen sc1
L_arr_23:
  v_mov_b32 v234, 0
  s_cmp_lg_u32 s70, 3
  s_cbranch_scc1 L_pre_24
  buffer_atomic_add v234, v205, s[48:51], s96 offen sc0 sc1
L_pre_24:
  v_sub_u32 v14, v198, v197
  v_lshrrev_b32 v3, 3, v2
  v_and_b32 v5, 7, v2
  v_lshlrev_b32 v6, 4, v5
  v_lshl_add_u32 v8, v3, 12, v6
  v_xor_b32 v6, v5, v3
  v_lshlrev_b32 v6, 4, v6
  v_lshl_add_u32 v6, v3, 7, v6
  v_add_u32 v13, v14, v6
  v_lshrrev_b32 v6, 1, v4
  v_xor_b32 v6, v6, v5
  v_lshlrev_b32 v6, 4, v6
  v_and_b32_e64 v3, 15, v2
  v_lshl_add_u32 v6, v3, 7, v6
  v_and_b32_e64 v3, 1, v4
  v_lshl_add_u32 v6, v3, 3, v6
  v_add_u32 v9, v14, v6
  v_xor_b32 v10, 32, v9
  v_xor_b32_e64 v11, 64, v9
  v_xor_b32 v12, 96, v9
  s_lshl_b32 s93, s88, 17
  s_lshl_b32 s94, s7, 7
  s_add_u32 s93, s93, s94
L_lpoll_25:
  ds_read_b32 v3, v206 offset:128
  s_waitcnt lgkmcnt(0)
L_pad_5:
  s_cmp_eq_u32 s101, 1
  s_cbranch_scc1 L_res_h
  v_cmp_ne_u32 vcc, 4, v3
  s_nop 0
  s_cbranch_vccnz L_lpoll_25
  v_mov_b32 v235, 0
  s_cmp_lg_u32 s70, 3
  s_cbranch_scc1 L_pre_26
  buffer_atomic_add v235, v205, s[48:51], s96 offen sc0 sc1
L_pre_26:
  ds_read_b64_tr_b16 v[64:65], v104 offset:40960
  ds_read_b64_tr_b16 v[66:67], v116 offset:40960
  ds_read_b64_tr_b16 v[68:69], v104 offset:45056
  ds_read_b64_tr_b16 v[70:71], v116 offset:45056
  ds_read_b64_tr_b16 v[72:73], v105 offset:40960
  ds_read_b64_tr_b16 v[74:75], v117 offset:40960
  ds_read_b64_tr_b16 v[76:77], v105 offset:45056
  ds_read_b64_tr_b16 v[78:79], v117 offset:45056
  s_waitcnt lgkmcnt(0)
  s_cmp_lg_u32 s70, 3
  s_cbranch_scc1 L_pollo_29
  s_mov_b32 s97, 200000
  v_mov_b32 v238, 0
  buffer_atomic_add v238, v205, s[48:51], s96 offen sc0 sc1
L_poll_27:
  s_waitcnt vmcnt(2)
  v_readfirstlane_b32 s71, v234
  s_nop 0
  s_cmp_ge_u32 s71, 16
  s_cbranch_scc1 L_polld_28
  v_mov_b32 v234, 0
  buffer_atomic_add v234, v205, s[48:51], s96 offen sc0 sc1
  s_waitcnt vmcnt(2)
  v_readfirstlane_b32 s71, v235
  s_nop 0
  s_cmp_ge_u32 s71, 16
  s_cbranch_scc1 L_polld_28
  v_mov_b32 v235, 0
  buffer_atomic_add v235, v205, s[48:51], s96 offen sc0 sc1
  s_waitcnt vmcnt(2)
  v_readfirstlane_b32 s71, v238
  s_nop 0
  s_cmp_ge_u32 s71, 16
  s_cbranch_scc1 L_polld_28
  v_mov_b32 v238, 0
  buffer_atomic_add v238, v205, s[48:51], s96 offen sc0 sc1
  s_sub_u32 s97, s97, 1
  s_cbranch_scc0 L_poll_27
L_polld_28:
  ds_write_b32 v206, v97 offset:68
  s_branch L_polle_30
L_pollo_29:
L_lpoll_31:
  ds_read_b32 v238, v206 offset:68
  s_waitcnt lgkmcnt(0)
  v_cmp_ne_u32_e64 vcc, 1, v238
  s_nop 0
  s_cbranch_vccnz L_lpoll_31
L_polle_30:
  buffer_load_dwordx4 v[128:131], v197, s[48:51], s38 offen offset:0 sc1
  buffer_load_dwordx4 v[132:135], v197, s[48:51], s39 offen offset:0 sc1
  buffer_load_dwordx4 v[136:139], v197, s[48:51], s38 offen offset:1024 sc1
  buffer_load_dwordx4 v[140:143], v197, s[48:51], s39 offen offset:1024 sc1
  buffer_load_dwordx4 v[144:147], v197, s[48:51], s38 offen offset:2048 sc1
  buffer_load_dwordx4 v[148:151], v197, s[48:51], s39 offen offset:2048 sc1
  buffer_load_dwordx4 v[152:155], v197, s[48:51], s38 offen offset:3072 sc1
  buffer_load_dwordx4 v[156:159], v197, s[48:51], s39 offen offset:3072 sc1
  s_waitcnt vmcnt(7)
  v_mfma_f32_16x16x32_bf16 v[32:35], v[64:67], v[128:131], 0
  ds_read_b64_tr_b16 v[80:81], v106 offset:40960
  s_xor_b32 s38, s38, 4096
  s_xor_b32 s39, s39, 4096
  s_waitcnt vmcnt(5)
  v_mfma_f32_16x16x32_bf16 v[32:35], v[68:71], v[136:139], v[32:35]
  ds_read_b64_tr_b16 v[82:83], v118 offset:40960
  buffer_load_dwordx4 v[160:163], v197, s[48:51], s38 offen offset:0 sc1
  s_waitcnt vmcnt(5)
  v_mfma_f32_16x16x32_bf16 v[48:51], v[68:71], v[140:143], 0
  ds_read_b64_tr_b16 v[84:85], v106 offset:45056
  v_mfma_f32_16x16x32_bf16 v[48:51], v[64:67], v[132:135], v[48:51]
  ds_read_b64_tr_b16 v[86:87], v118 offset:45056
  buffer_load_dwordx4 v[164:167], v197, s[48:51], s39 offen offset:0 sc1
  v_mfma_f32_16x16x32_bf16 v[52:55], v[72:75], v[132:135], 0
  ds_read_b64_tr_b16 v[88:89], v107 offset:40960
  v_mfma_f32_16x16x32_bf16 v[52:55], v[76:79], v[140:143], v[52:55]
  ds_read_b64_tr_b16 v[90:91], v119 offset:40960
  buffer_load_dwordx4 v[168:171], v197, s[48:51], s38 offen offset:1024 sc1
  v_mfma_f32_16x16x32_bf16 v[36:39], v[76:79], v[136:139], 0
  ds_read_b64_tr_b16 v[92:93], v107 offset:45056
  v_mfma_f32_16x16x32_bf16 v[36:39], v[72:75], v[128:131], v[36:39]
  ds_read_b64_tr_b16 v[94:95], v119 offset:45056
  buffer_load_dwordx4 v[172:175], v197, s[48:51], s39 offen offset:1024 sc1
  s_waitcnt lgkmcnt(6)
  v_mfma_f32_16x16x32_bf16 v[40:43], v[80:83], v[128:131], 0
  ds_read_b64_tr_b16 v[64:65], v104 offset:49152
  s_waitcnt lgkmcnt(5)
  v_mfma_f32_16x16x32_bf16 v[40:43], v[84:87], v[136:139], v[40:43]
  ds_read_b64_tr_b16 v[66:67], v116 offset:49152
  buffer_load_dwordx4 v[176:179], v197, s[48:51], s38 offen offset:2048 sc1
  v_mfma_f32_16x16x32_bf16 v[56:59], v[84:87], v[140:143], 0
  ds_read_b64_tr_b16 v[68:69], v104 offset:53248
  v_mfma_f32_16x16x32_bf16 v[56:59], v[80:83], v[132:135], v[56:59]
  ds_read_b64_tr_b16 v[70:71], v116 offset:53248
  buffer_load_dwordx4 v[180:183], v197, s[48:51], s39 offen offset:2048 sc1
  s_waitcnt lgkmcnt(6)
  v_mfma_f32_16x16x32_bf16 v[60:63], v[88:91], v[132:135], 0
  ds_read_b64_tr_b16 v[72:73], v105 offset:49152
  s_waitcnt lgkmcnt(5)
  v_mfma_f32_16x16x32_bf16 v[60:63], v[92:95], v[140:143], v[60:63]
  ds_read_b64_tr_b16 v[74:75], v117 offset:49152
  buffer_load_dwordx4 v[184:187], v197, s[48:51], s38 offen offset:3072 sc1
  v_mfma_f32_16x16x32_bf16 v[44:47], v[92:95], v[136:139], 0
  ds_read_b64_tr_b16 v[76:77], v105 offset:53248
  v_mfma_f32_16x16x32_bf16 v[44:47], v[88:91], v[128:131], v[44:47]
  ds_read_b64_tr_b16 v[78:79], v117 offset:53248
  buffer_load_dwordx4 v[188:191], v197, s[48:51], s39 offen offset:3072 sc1
  s_waitcnt vmcnt(11) lgkmcnt(6)
  v_mfma_f32_16x16x32_bf16 v[32:35], v[64:67], v[144:147], v[32:35]
  ds_read_b64_tr_b16 v[80:81], v106 offset:49152
  s_xor_b32 s38, s38, 12288
  s_xor_b32 s39, s39, 12288
  s_waitcnt vmcnt(9) lgkmcnt(5)
  v_mfma_f32_16x16x32_bf16 v[32:35], v[68:71], v[152:155], v[32:35]
  ds_read_b64_tr_b16 v[82:83], v118 offset:49152
  buffer_load_dwordx4 v[128:131], v197, s[48:51], s38 offen offset:0 sc1
  s_waitcnt vmcnt(9)
  v_mfma_f32_16x16x32_bf16 v[48:51], v[68:71], v[156:159], v[48:51]
  ds_read_b64_tr_b16 v[84:85], v106 offset:53248
  v_mfma_f32_16x16x32_bf16 v[48:51], v[64:67], v[148:151], v[48:51]
  ds_read_b64_tr_b16 v[86:87], v118 offset:53248
  s_waitcnt lgkmcnt(6)
  v_mfma_f32_16x16x32_bf16 v[52:55], v[72:75], v[148:151], v[52:55]
  ds_read_b64_tr_b16 v[88:89], v107 offset:49152
  s_waitcnt lgkmcnt(5)
  v_mfma_f32_16x16x32_bf16 v[52:55], v[76:79], v[156:159], v[52:55]
  ds_read_b64_tr_b16 v[90:91], v119 offset:49152
  buffer_load_dwordx4 v[132:135], v197, s[48:51], s39 offen offset:0 sc1
  v_mfma_f32_16x16x32_bf16 v[36:39], v[76:79], v[152:155], v[36:39]
  ds_read_b64_tr_b16 v[92:93], v107 offset:53248
  v_mfma_f32_16x16x32_bf16 v[36:39], v[72:75], v[144:147], v[36:39]
  ds_read_b64_tr_b16 v[94:95], v119 offset:53248
  s_waitcnt lgkmcnt(6)
  v_mfma_f32_16x16x32_bf16 v[40:43], v[80:83], v[144:147], v[40:43]
  ds_read_b64_tr_b16 v[64:65], v108 offset:0
  s_waitcnt lgkmcnt(5)
  v_mfma_f32_16x16x32_bf16 v[40:43], v[84:87], v[152:155], v[40:43]
  ds_read_b64_tr_b16 v[66:67], v120 offset:0
  buffer_load_dwordx4 v[136:139], v197, s[48:51], s38 offen offset:1024 sc1
  v_mfma_f32_16x16x32_bf16 v[56:59], v[84:87], v[156:159], v[56:59]
  ds_read_b64_tr_b16 v[68:69], v108 offset:4096
  v_mfma_f32_16x16x32_bf16 v[56:59], v[80:83], v[148:151], v[56:59]
  ds_read_b64_tr_b16 v[70:71], v120 offset:4096
  s_waitcnt lgkmcnt(6)
  v_mfma_f32_16x16x32_bf16 v[60:63], v[88:91], v[148:151], v[60:63]
  ds_read_b64_tr_b16 v[72:73], v109 offset:0
  s_waitcnt lgkmcnt(5)
  v_mfma_f32_16x16x32_bf16 v[60:63], v[92:95], v[156:159], v[60:63]
  ds_read_b64_tr_b16 v[74:75], v121 offset:0
  buffer_load_dwordx4 v[140:143], v197, s[48:51], s39 offen offset:1024 sc1
  v_mfma_f32_16x16x32_bf16 v[44:47], v[92:95], v[152:155], v[44:47]
  ds_read_b64_tr_b16 v[76:77], v109 offset:4096
  v_mfma_f32_16x16x32_bf16 v[44:47], v[88:91], v[144:147], v[44:47]
  ds_read_b64_tr_b16 v[78:79], v121 offset:4096
  s_waitcnt vmcnt(11) lgkmcnt(6)
  v_mfma_f32_16x16x32_bf16 v[32:35], v[64:67], v[160:163], v[32:35]
  ds_read_b64_tr_b16 v[80:81], v110 offset:0
  s_waitcnt vmcnt(9) lgkmcnt(5)
  v_mfma_f32_16x16x32_bf16 v[32:35], v[68:71], v[168:171], v[32:35]
  ds_read_b64_tr_b16 v[82:83], v122 offset:0
  buffer_load_dwordx4 v[144:147], v197, s[48:51], s38 offen offset:2048 sc1
  s_waitcnt vmcnt(9)
  v_mfma_f32_16x16x32_bf16 v[48:51], v[68:71], v[172:175], v[48:51]
  ds_read_b64_tr_b16 v[84:85], v110 offset:4096
  v_mfma_f32_16x16x32_bf16 v[48:51], v[64:67], v[164:167], v[48:51]
  ds_read_b64_tr_b16 v[86:87], v122 offset:4096
  s_waitcnt lgkmcnt(6)
  v_mfma_f32_16x16x32_bf16 v[52:55], v[72:75], v[164:167], v[52:55]
  ds_read_b64_tr_b16 v[88:89], v111 offset:0
  s_waitcnt lgkmcnt(5)
  v_mfma_f32_16x16x32_bf16 v[52:55], v[76:79], v[172:175], v[52:55]
  ds_read_b64_tr_b16 v[90:91], v123 offset:0
  buffer_load_dwordx4 v[148:151], v197, s[48:51], s39 offen offset:2048 sc1
  v_mfma_f32_16x16x32_bf16 v[36:39], v[76:79], v[168:171], v[36:39]
  ds_read_b64_tr_b16 v[92:93], v111 offset:4096
  v_mfma_f32_16x16x32_bf16 v[36:39], v[72:75], v[160:163], v[36:39]
  ds_read_b64_tr_b16 v[94:95], v123 offset:4096
  s_waitcnt lgkmcnt(6)
  v_mfma_f32_16x16x32_bf16 v[40:43], v[80:83], v[160:163], v[40:43]
  ds_read_b64_tr_b16 v[64:65], v108 offset:8192
  s_waitcnt lgkmcnt(5)
  v_mfma_f32_16x16x32_bf16 v[40:43], v[84:87], v[168:171], v[40:43]
  ds_read_b64_tr_b16 v[66:67], v120 offset:8192
  buffer_load_dwordx4 v[152:155], v197, s[48:51], s38 offen offset:3072 sc1
  v_mfma_f32_16x16x32_bf16 v[56:59], v[84:87], v[172:175], v[56:59]
  ds_read_b64_tr_b16 v[68:69], v108 offset:12288
  v_mfma_f32_16x16x32_bf16 v[56:59], v[80:83], v[164:167], v[56:59]
  ds_read_b64_tr_b16 v[70:71], v120 offset:12288
  s_waitcnt lgkmcnt(6)
  v_mfma_f32_16x16x32_bf16 v[60:63], v[88:91], v[164:167], v[60:63]
  ds_read_b64_tr_b16 v[72:73], v109 offset:8192
  s_waitcnt lgkmcnt(5)
  v_mfma_f32_16x16x32_bf16 v[60:63], v[92:95], v[172:175], v[60:63]
  ds_read_b64_tr_b16 v[74:75], v121 offset:8192
  buffer_load_dwordx4 v[156:159], v197, s[48:51], s39 offen offset:3072 sc1
  v_mfma_f32_16x16x32_bf16 v[44:47], v[92:95], v[168:171], v[44:47]
  ds_read_b64_tr_b16 v[76:77], v109 offset:12288
  v_mfma_f32_16x16x32_bf16 v[44:47], v[88:91], v[160:163], v[44:47]
  ds_read_b64_tr_b16 v[78:79], v121 offset:12288
  s_waitcnt vmcnt(11) lgkmcnt(6)
  v_mfma_f32_16x16x32_bf16 v[32:35], v[64:67], v[176:179], v[32:35]
  ds_read_b64_tr_b16 v[80:81], v110 offset:8192
  s_xor_b32 s38, s38, 4096
  s_xor_b32 s39, s39, 4096
  s_waitcnt vmcnt(9) lgkmcnt(5)
  v_mfma_f32_16x16x32_bf16 v[32:35], v[68:71], v[184:187], v[32:35]
  ds_read_b64_tr_b16 v[82:83], v122 offset:8192
  buffer_load_dwordx4 v[160:163], v197, s[48:51], s38 offen offset:0 sc1
  s_waitcnt vmcnt(9)
  v_mfma_f32_16x16x32_bf16 v[48:51], v[68:71], v[188:191], v[48:51]
  ds_read_b64_tr_b16 v[84:85], v110 offset:12288
  v_mfma_f32_16x16x32_bf16 v[48:51], v[64:67], v[180:183], v[48:51]
  ds_read_b64_tr_b16 v[86:87], v122 offset:12288
  s_waitcnt lgkmcnt(6)
  v_mfma_f32_16x16x32_bf16 v[52:55], v[72:75], v[180:183], v[52:55]
  ds_read_b64_tr_b16 v[88:89], v111 offset:8192
  s_waitcnt lgkmcnt(5)
  v_mfma_f32_16x16x32_bf16 v[52:55], v[76:79], v[188:191], v[52:55]
  ds_read_b64_tr_b16 v[90:91], v123 offset:8192
  buffer_load_dwordx4 v[164:167], v197, s[48:51], s39 offen offset:0 sc1
  v_mfma_f32_16x16x32_bf16 v[36:39], v[76:79], v[184:187], v[36:39]
  ds_read_b64_tr_b16 v[92:93], v111 offset:12288
  v_mfma_f32_16x16x32_bf16 v[36:39], v[72:75], v[176:179], v[36:39]
  ds_read_b64_tr_b16 v[94:95], v123 offset:12288
  s_waitcnt lgkmcnt(6)
  v_mfma_f32_16x16x32_bf16 v[40:43], v[80:83], v[176:179], v[40:43]
  ds_read_b64_tr_b16 v[64:65], v108 offset:16384
  s_waitcnt lgkmcnt(5)
  v_mfma_f32_16x16x32_bf16 v[40:43], v[84:87], v[184:187], v[40:43]
  ds_read_b64_tr_b16 v[66:67], v120 offset:16384
  buffer_load_dwordx4 v[168:171], v197, s[48:51], s38 offen offset:1024 sc1
  v_mfma_f32_16x16x32_bf16 v[56:59], v[84:87], v[188:191], v[56:59]
  ds_read_b64_tr_b16 v[68:69], v108 offset:20480
  v_mfma_f32_16x16x32_bf16 v[56:59], v[80:83], v[180:183], v[56:59]
  ds_read_b64_tr_b16 v[70:71], v120 offset:20480
  s_waitcnt lgkmcnt(6)
  v_mfma_f32_16x16x32_bf16 v[60:63], v[88:91], v[180:183], v[60:63]
  ds_read_b64_tr_b16 v[72:73], v109 offset:16384
  s_waitcnt lgkmcnt(5)
  v_mfma_f32_16x16x32_bf16 v[60:63], v[92:95], v[188:191], v[60:63]
  ds_read_b64_tr_b16 v[74:75], v121 offset:16384
  buffer_load_dwordx4 v[172:175], v197, s[48:51], s39 offen offset:1024 sc1
  v_mfma_f32_16x16x32_bf16 v[44:47], v[92:95], v[184:187], v[44:47]
  ds_read_b64_tr_b16 v[76:77], v109 offset:20480
  v_mfma_f32_16x16x32_bf16 v[44:47], v[88:91], v[176:179], v[44:47]
  ds_read_b64_tr_b16 v[78:79], v121 offset:20480
  s_waitcnt vmcnt(11) lgkmcnt(6)
  v_mfma_f32_16x16x32_bf16 v[32:35], v[64:67], v[128:131], v[32:35]
  ds_read_b64_tr_b16 v[80:81], v110 offset:16384
  s_waitcnt vmcnt(9) lgkmcnt(5)
  v_mfma_f32_16x16x32_bf16 v[32:35], v[68:71], v[136:139], v[32:35]
  ds_read_b64_tr_b16 v[82:83], v122 offset:16384
  buffer_load_dwordx4 v[176:179], v197, s[48:51], s38 offen offset:2048 sc1
  s_waitcnt vmcnt(9)
  v_mfma_f32_16x16x32_bf16 v[48:51], v[68:71], v[140:143], v[48:51]
  ds_read_b64_tr_b16 v[84:85], v110 offset:20480
  v_mfma_f32_16x16x32_bf16 v[48:51], v[64:67], v[132:135], v[48:51]
  ds_read_b64_tr_b16 v[86:87], v122 offset:20480
  s_waitcnt lgkmcnt(6)
  v_mfma_f32_16x16x32_bf16 v[52:55], v[72:75], v[132:135], v[52:55]
  ds_read_b64_tr_b16 v[88:89], v111 offset:16384
  s_waitcnt lgkmcnt(5)
  v_mfma_f32_16x16x32_bf16 v[52:55], v[76:79], v[140:143], v[52:55]
  ds_read_b64_tr_b16 v[90:91], v123 offset:16384
  buffer_load_dwordx4 v[180:183], v197, s[48:51], s39 offen offset:2048 sc1
  v_mfma_f32_16x16x32_bf16 v[36:39], v[76:79], v[136:139], v[36:39]
  ds_read_b64_tr_b16 v[92:93], v111 offset:20480
  v_mfma_f32_16x16x32_bf16 v[36:39], v[72:75], v[128:131], v[36:39]
  ds_read_b64_tr_b16 v[94:95], v123 offset:20480
  s_waitcnt lgkmcnt(6)
  v_mfma_f32_16x16x32_bf16 v[40:43], v[80:83], v[128:131], v[40:43]
  ds_read_b64_tr_b16 v[64:65], v108 offset:24576
  s_waitcnt lgkmcnt(5)
  v_mfma_f32_16x16x32_bf16 v[40:43], v[84:87], v[136:139], v[40:43]
  ds_read_b64_tr_b16 v[66:67], v120 offset:24576
  buffer_load_dwordx4 v[184:187], v197, s[48:51], s38 offen offset:3072 sc1
  v_mfma_f32_16x16x32_bf16 v[56:59], v[84:87], v[140:143], v[56:59]
  ds_read_b64_tr_b16 v[68:69], v108 offset:28672
  v_mfma_f32_16x16x32_bf16 v[56:59], v[80:83], v[132:135], v[56:59]
  ds_read_b64_tr_b16 v[70:71], v120 offset:28672
  s_waitcnt lgkmcnt(6)
  v_mfma_f32_16x16x32_bf16 v[60:63], v[88:91], v[132:135], v[60:63]
  ds_read_b64_tr_b16 v[72:73], v109 offset:24576
  s_waitcnt lgkmcnt(5)
  v_mfma_f32_16x16x32_bf16 v[60:63], v[92:95], v[140:143], v[60:63]
  ds_read_b64_tr_b16 v[74:75], v121 offset:24576
  buffer_load_dwordx4 v[188:191], v197, s[48:51], s39 offen offset:3072 sc1
  v_mfma_f32_16x16x32_bf16 v[44:47], v[92:95], v[136:139], v[44:47]
  ds_read_b64_tr_b16 v[76:77], v109 offset:28672
  v_mfma_f32_16x16x32_bf16 v[44:47], v[88:91], v[128:131], v[44:47]
  ds_read_b64_tr_b16 v[78:79], v121 offset:28672
  s_waitcnt vmcnt(11) lgkmcnt(6)
  v_mfma_f32_16x16x32_bf16 v[32:35], v[64:67], v[144:147], v[32:35]
  ds_read_b64_tr_b16 v[80:81], v110 offset:24576
  s_xor_b32 s38, s38, 28672
  s_xor_b32 s39, s39, 28672
  s_waitcnt vmcnt(9) lgkmcnt(5)
  v_mfma_f32_16x16x32_bf16 v[32:35], v[68:71], v[152:155], v[32:35]
  ds_read_b64_tr_b16 v[82:83], v122 offset:24576
  buffer_load_dwordx4 v[128:131], v197, s[48:51], s38 offen offset:0 sc1
  s_waitcnt vmcnt(9)
  v_mfma_f32_16x16x32_bf16 v[48:51], v[68:71], v[156:159], v[48:51]
  ds_read_b64_tr_b16 v[84:85], v110 offset:28672
  v_mfma_f32_16x16x32_bf16 v[48:51], v[64:67], v[148:151], v[48:51]
  ds_read_b64_tr_b16 v[86:87], v122 offset:28672
  s_waitcnt lgkmcnt(6)
  v_mfma_f32_16x16x32_bf16 v[52:55], v[72:75], v[148:151], v[52:55]
  ds_read_b64_tr_b16 v[88:89], v111 offset:24576
  s_waitcnt lgkmcnt(5)
  v_mfma_f32_16x16x32_bf16 v[52:55], v[76:79], v[156:159], v[52:55]
  ds_read_b64_tr_b16 v[90:91], v123 offset:24576
  buffer_load_dwordx4 v[132:135], v197, s[48:51], s39 offen offset:0 sc1
  v_mfma_f32_16x16x32_bf16 v[36:39], v[76:79], v[152:155], v[36:39]
  ds_read_b64_tr_b16 v[92:93], v111 offset:28672
  v_mfma_f32_16x16x32_bf16 v[36:39], v[72:75], v[144:147], v[36:39]
  ds_read_b64_tr_b16 v[94:95], v123 offset:28672
  s_waitcnt lgkmcnt(6)
  v_mfma_f32_16x16x32_bf16 v[40:43], v[80:83], v[144:147], v[40:43]
  ds_read_b64_tr_b16 v[64:65], v108 offset:32768
  s_waitcnt lgkmcnt(5)
  v_mfma_f32_16x16x32_bf16 v[40:43], v[84:87], v[152:155], v[40:43]
  ds_read_b64_tr_b16 v[66:67], v120 offset:32768
  buffer_load_dwordx4 v[136:139], v197, s[48:51], s38 offen offset:1024 sc1
  v_mfma_f32_16x16x32_bf16 v[56:59], v[84:87], v[156:159], v[56:59]
  ds_read_b64_tr_b16 v[68:69], v108 offset:36864
  v_mfma_f32_16x16x32_bf16 v[56:59], v[80:83], v[148:151], v[56:59]
  ds_read_b64_tr_b16 v[70:71], v120 offset:36864
  s_waitcnt lgkmcnt(6)
  v_mfma_f32_16x16x32_bf16 v[60:63], v[88:91], v[148:151], v[60:63]
  ds_read_b64_tr_b16 v[72:73], v109 offset:32768
  s_waitcnt lgkmcnt(5)
  v_mfma_f32_16x16x32_bf16 v[60:63], v[92:95], v[156:159], v[60:63]
  ds_read_b64_tr_b16 v[74:75], v121 offset:32768
  buffer_load_dwordx4 v[140:143], v197, s[48:51], s39 offen offset:1024 sc1
  v_mfma_f32_16x16x32_bf16 v[44:47], v[92:95], v[152:155], v[44:47]
  ds_read_b64_tr_b16 v[76:77], v109 offset:36864
  v_mfma_f32_16x16x32_bf16 v[44:47], v[88:91], v[144:147], v[44:47]
  ds_read_b64_tr_b16 v[78:79], v121 offset:36864
  s_waitcnt vmcnt(11) lgkmcnt(6)
  v_mfma_f32_16x16x32_bf16 v[32:35], v[64:67], v[160:163], v[32:35]
  ds_read_b32 v3, v206 offset:48
  ds_read_b64_tr_b16 v[80:81], v110 offset:32768
  s_waitcnt vmcnt(9) lgkmcnt(6)
  v_mfma_f32_16x16x32_bf16 v[32:35], v[68:71], v[168:171], v[32:35]
  ds_read_b64_tr_b16 v[82:83], v122 offset:32768
  buffer_load_dwordx4 v[144:147], v197, s[48:51], s38 offen offset:2048 sc1
  s_waitcnt vmcnt(9)
  v_mfma_f32_16x16x32_bf16 v[48:51], v[68:71], v[172:175], v[48:51]
  ds_read_b64_tr_b16 v[84:85], v110 offset:36864
  v_mfma_f32_16x16x32_bf16 v[48:51], v[64:67], v[164:167], v[48:51]
  ds_read_b64_tr_b16 v[86:87], v122 offset:36864
  s_waitcnt lgkmcnt(7)
  v_mfma_f32_16x16x32_bf16 v[52:55], v[72:75], v[164:167], v[52:55]
  ds_read_b64_tr_b16 v[88:89], v111 offset:32768
  s_waitcnt lgkmcnt(6)
  v_mfma_f32_16x16x32_bf16 v[52:55], v[76:79], v[172:175], v[52:55]
  ds_read_b64_tr_b16 v[90:91], v123 offset:32768
  buffer_load_dwordx4 v[148:151], v197, s[48:51], s39 offen offset:2048 sc1
  v_mfma_f32_16x16x32_bf16 v[36:39], v[76:79], v[168:171], v[36:39]
  ds_read_b64_tr_b16 v[92:93], v111 offset:36864
  s_waitcnt lgkmcnt(7)
  v_cmp_ne_u32_e64 vcc, 4, v3
  v_mfma_f32_16x16x32_bf16 v[36:39], v[72:75], v[160:163], v[36:39]
  ds_read_b64_tr_b16 v[94:95], v123 offset:36864
  s_cbranch_vccnz L_wf_32
L_wf_32r:
  s_waitcnt lgkmcnt(6)
  v_mfma_f32_16x16x32_bf16 v[40:43], v[80:83], v[160:163], v[40:43]
  ds_read_b64_tr_b16 v[64:65], v100 offset:40960
  s_waitcnt lgkmcnt(5)
  v_mfma_f32_16x16x32_bf16 v[40:43], v[84:87], v[168:171], v[40:43]
  ds_read_b64_tr_b16 v[66:67], v112 offset:40960
  buffer_load_dwordx4 v[152:155], v197, s[48:51], s38 offen offset:3072 sc1
  v_mfma_f32_16x16x32_bf16 v[56:59], v[84:87], v[172:175], v[56:59]
  ds_read_b64_tr_b16 v[68:69], v100 offset:45056
  v_mfma_f32_16x16x32_bf16 v[56:59], v[80:83], v[164:167], v[56:59]
  ds_read_b64_tr_b16 v[70:71], v112 offset:45056
  s_waitcnt lgkmcnt(6)
  v_mfma_f32_16x16x32_bf16 v[60:63], v[88:91], v[164:167], v[60:63]
  ds_read_b64_tr_b16 v[72:73], v101 offset:40960
  s_waitcnt lgkmcnt(5)
  v_mfma_f32_16x16x32_bf16 v[60:63], v[92:95], v[172:175], v[60:63]
  ds_read_b64_tr_b16 v[74:75], v113 offset:40960
  buffer_load_dwordx4 v[156:159], v197, s[48:51], s39 offen offset:3072 sc1
  v_mfma_f32_16x16x32_bf16 v[44:47], v[92:95], v[168:171], v[44:47]
  ds_read_b64_tr_b16 v[76:77], v101 offset:45056
  v_mfma_f32_16x16x32_bf16 v[44:47], v[88:91], v[160:163], v[44:47]
  ds_read_b64_tr_b16 v[78:79], v113 offset:45056
  s_waitcnt vmcnt(11) lgkmcnt(6)
  v_mfma_f32_16x16x32_bf16 v[32:35], v[64:67], v[176:179], v[32:35]
  ds_read_b64_tr_b16 v[80:81], v102 offset:40960
  s_xor_b32 s38, s38, 4096
  s_xor_b32 s39, s39, 4096
  s_waitcnt vmcnt(9) lgkmcnt(5)
  v_mfma_f32_16x16x32_bf16 v[32:35], v[68:71], v[184:187], v[32:35]
  ds_read_b64_tr_b16 v[82:83], v114 offset:40960
  buffer_load_dwordx4 v[160:163], v197, s[48:51], s38 offen offset:0 sc1
  s_waitcnt vmcnt(9)
  v_mfma_f32_16x16x32_bf16 v[48:51], v[68:71], v[188:191], v[48:51]
  ds_read_b64_tr_b16 v[84:85], v102 offset:45056
  v_mfma_f32_16x16x32_bf16 v[48:51], v[64:67], v[180:183], v[48:51]
  ds_read_b64_tr_b16 v[86:87], v114 offset:45056
  s_waitcnt lgkmcnt(6)
  v_mfma_f32_16x16x32_bf16 v[52:55], v[72:75], v[180:183], v[52:55]
  ds_read_b64_tr_b16 v[88:89], v103 offset:40960
  s_waitcnt lgkmcnt(5)
  v_mfma_f32_16x16x32_bf16 v[52:55], v[76:79], v[188:191], v[52:55]
  ds_read_b64_tr_b16 v[90:91], v115 offset:40960
  buffer_load_dwordx4 v[164:167], v197, s[48:51], s39 offen offset:0 sc1
  v_mfma_f32_16x16x32_bf16 v[36:39], v[76:79], v[184:187], v[36:39]
  ds_read_b64_tr_b16 v[92:93], v103 offset:45056
  v_mfma_f32_16x16x32_bf16 v[36:39], v[72:75], v[176:179], v[36:39]
  ds_read_b64_tr_b16 v[94:95], v115 offset:45056
  s_waitcnt lgkmcnt(6)
  v_mfma_f32_16x16x32_bf16 v[40:43], v[80:83], v[176:179], v[40:43]
  ds_read_b64_tr_b16 v[64:65], v100 offset:49152
  s_waitcnt lgkmcnt(5)
  v_mfma_f32_16x16x32_bf16 v[40:43], v[84:87], v[184:187], v[40:43]
  ds_read_b64_tr_b16 v[66:67], v112 offset:49152
  buffer_load_dwordx4 v[168:171], v197, s[48:51], s38 offen offset:1024 sc1
  v_mfma_f32_16x16x32_bf16 v[56:59], v[84:87], v[188:191], v[56:59]
  ds_read_b64_tr_b16 v[68:69], v100 offset:53248
  v_mfma_f32_16x16x32_bf16 v[56:59], v[80:83], v[180:183], v[56:59]
  ds_read_b64_tr_b16 v[70:71], v112 offset:53248
  s_waitcnt lgkmcnt(6)
  v_mfma_f32_16x16x32_bf16 v[60:63], v[88:91], v[180:183], v[60:63]
  ds_read_b64_tr_b16 v[72:73], v101 offset:49152
  s_waitcnt lgkmcnt(5)
  v_mfma_f32_16x16x32_bf16 v[60:63], v[92:95], v[188:191], v[60:63]
  ds_read_b64_tr_b16 v[74:75], v113 offset:49152
  buffer_load_dwordx4 v[172:175], v197, s[48:51], s39 offen offset:1024 sc1
  v_mfma_f32_16x16x32_bf16 v[44:47], v[92:95], v[184:187], v[44:47]
  ds_read_b64_tr_b16 v[76:77], v101 offset:53248
  v_mfma_f32_16x16x32_bf16 v[44:47], v[88:91], v[176:179], v[44:47]
  ds_read_b64_tr_b16 v[78:79], v113 offset:53248
  s_waitcnt vmcnt(11) lgkmcnt(6)
  v_mfma_f32_16x16x32_bf16 v[32:35], v[64:67], v[128:131], v[32:35]
  ds_read_b64_tr_b16 v[80:81], v102 offset:49152
  s_waitcnt vmcnt(9) lgkmcnt(5)
  v_mfma_f32_16x16x32_bf16 v[32:35], v[68:71], v[136:139], v[32:35]
  ds_read_b64_tr_b16 v[82:83], v114 offset:49152
  buffer_load_dwordx4 v[176:179], v197, s[48:51], s38 offen offset:2048 sc1
  s_waitcnt vmcnt(9)
  v_mfma_f32_16x16x32_bf16 v[48:51], v[68:71], v[140:143], v[48:51]
  ds_read_b64_tr_b16 v[84:85], v102 offset:53248
  v_mfma_f32_16x16x32_bf16 v[48:51], v[64:67], v[132:135], v[48:51]
  ds_read_b64_tr_b16 v[86:87], v114 offset:53248
  s_waitcnt lgkmcnt(6)
  v_mfma_f32_16x16x32_bf16 v[52:55], v[72:75], v[132:135], v[52:55]
  ds_read_b64_tr_b16 v[88:89], v103 offset:49152
  s_waitcnt lgkmcnt(5)
  v_mfma_f32_16x16x32_bf16 v[52:55], v[76:79], v[140:143], v[52:55]
  ds_read_b64_tr_b16 v[90:91], v115 offset:49152
  buffer_load_dwordx4 v[180:183], v197, s[48:51], s39 offen offset:2048 sc1
  v_mfma_f32_16x16x32_bf16 v[36:39], v[76:79], v[136:139], v[36:39]
  ds_read_b64_tr_b16 v[92:93], v103 offset:53248
  v_mfma_f32_16x16x32_bf16 v[36:39], v[72:75], v[128:131], v[36:39]
  ds_read_b64_tr_b16 v[94:95], v115 offset:53248
  s_waitcnt lgkmcnt(6)
  v_mfma_f32_16x16x32_bf16 v[40:43], v[80:83], v[128:131], v[40:43]
  ds_read_b64_tr_b16 v[64:65], v100 offset:57344
  ds_write_b32 v199, v97 offset:80
  s_waitcnt lgkmcnt(6)
  v_mfma_f32_16x16x32_bf16 v[40:43], v[84:87], v[136:139], v[40:43]
  ds_read_b64_tr_b16 v[66:67], v112 offset:57344
  buffer_load_dwordx4 v[184:187], v197, s[48:51], s38 offen offset:3072 sc1
  v_mfma_f32_16x16x32_bf16 v[56:59], v[84:87], v[140:143], v[56:59]
  ds_read_b64_tr_b16 v[68:69], v104 offset:0
  v_mfma_f32_16x16x32_bf16 v[56:59], v[80:83], v[132:135], v[56:59]
  ds_read_b64_tr_b16 v[70:71], v116 offset:0
  s_waitcnt lgkmcnt(7)
  v_mfma_f32_16x16x32_bf16 v[60:63], v[88:91], v[132:135], v[60:63]
  ds_read_b64_tr_b16 v[72:73], v101 offset:57344
  s_waitcnt lgkmcnt(6)
  v_mfma_f32_16x16x32_bf16 v[60:63], v[92:95], v[140:143], v[60:63]
  ds_read_b64_tr_b16 v[74:75], v113 offset:57344
  buffer_load_dwordx4 v[188:191], v197, s[48:51], s39 offen offset:3072 sc1
  v_mfma_f32_16x16x32_bf16 v[44:47], v[92:95], v[136:139], v[44:47]
  ds_read_b64_tr_b16 v[76:77], v105 offset:0
  v_mfma_f32_16x16x32_bf16 v[44:47], v[88:91], v[128:131], v[44:47]
  ds_read_b64_tr_b16 v[78:79], v117 offset:0
  s_waitcnt vmcnt(11) lgkmcnt(6)
  v_mfma_f32_16x16x32_bf16 v[32:35], v[64:67], v[144:147], v[32:35]
  ds_read_b64_tr_b16 v[80:81], v102 offset:57344
  s_xor_b32 s38, s38, 12288
  s_xor_b32 s39, s39, 12288
  s_waitcnt vmcnt(9) lgkmcnt(5)
  v_mfma_f32_16x16x32_bf16 v[32:35], v[68:71], v[152:155], v[32:35]
  ds_read_b64_tr_b16 v[82:83], v114 offset:57344
  buffer_load_dwordx4 v[128:131], v197, s[48:51], s38 offen offset:0 sc1
  s_waitcnt vmcnt(9)
  v_mfma_f32_16x16x32_bf16 v[48:51], v[68:71], v[156:159], v[48:51]
  ds_read_b64_tr_b16 v[84:85], v106 offset:0
  v_mfma_f32_16x16x32_bf16 v[48:51], v[64:67], v[148:151], v[48:51]
  ds_read_b64_tr_b16 v[86:87], v118 offset:0
  s_waitcnt lgkmcnt(6)
  v_mfma_f32_16x16x32_bf16 v[52:55], v[72:75], v[148:151], v[52:55]
  ds_read_b64_tr_b16 v[88:89], v103 offset:57344
  s_waitcnt lgkmcnt(5)
  v_mfma_f32_16x16x32_bf16 v[52:55], v[76:79], v[156:159], v[52:55]
  ds_read_b64_tr_b16 v[90:91], v115 offset:57344
  buffer_load_dwordx4 v[132:135], v197, s[48:51], s39 offen offset:0 sc1
  v_mfma_f32_16x16x32_bf16 v[36:39], v[76:79], v[152:155], v[36:39]
  ds_read_b64_tr_b16 v[92:93], v107 offset:0
  v_mfma_f32_16x16x32_bf16 v[36:39], v[72:75], v[144:147], v[36:39]
  ds_read_b64_tr_b16 v[94:95], v119 offset:0
  s_waitcnt lgkmcnt(6)
  v_mfma_f32_16x16x32_bf16 v[40:43], v[80:83], v[144:147], v[40:43]
  ds_read_b64_tr_b16 v[64:65], v104 offset:4096
  s_waitcnt lgkmcnt(5)
  v_mfma_f32_16x16x32_bf16 v[40:43], v[84:87], v[152:155], v[40:43]
  ds_read_b64_tr_b16 v[66:67], v116 offset:4096
  buffer_load_dwordx4 v[136:139], v197, s[48:51], s38 offen offset:1024 sc1
  v_mfma_f32_16x16x32_bf16 v[56:59], v[84:87], v[156:159], v[56:59]
  ds_read_b64_tr_b16 v[68:69], v104 offset:8192
  v_mfma_f32_16x16x32_bf16 v[56:59], v[80:83], v[148:151], v[56:59]
  ds_read_b64_tr_b16 v[70:71], v116 offset:8192
  s_waitcnt lgkmcnt(6)
  v_mfma_f32_16x16x32_bf16 v[60:63], v[88:91], v[148:151], v[60:63]
  ds_read_b64_tr_b16 v[72:73], v105 offset:4096
  s_waitcnt lgkmcnt(5)
  v_mfma_f32_16x16x32_bf16 v[60:63], v[92:95], v[156:159], v[60:63]
  ds_read_b64_tr_b16 v[74:75], v117 offset:4096
  buffer_load_dwordx4 v[140:143], v197, s[48:51], s39 offen offset:1024 sc1
  v_mfma_f32_16x16x32_bf16 v[44:47], v[92:95], v[152:155], v[44:47]
  ds_read_b64_tr_b16 v[76:77], v105 offset:8192
  v_mfma_f32_16x16x32_bf16 v[44:47], v[88:91], v[144:147], v[44:47]
  ds_read_b64_tr_b16 v[78:79], v117 offset:8192
  s_waitcnt vmcnt(11) lgkmcnt(6)
  v_mfma_f32_16x16x32_bf16 v[32:35], v[64:67], v[160:163], v[32:35]
  ds_read_b64_tr_b16 v[80:81], v106 offset:4096
  s_waitcnt vmcnt(9) lgkmcnt(5)
  v_mfma_f32_16x16x32_bf16 v[32:35], v[68:71], v[168:171], v[32:35]
  ds_read_b64_tr_b16 v[82:83], v118 offset:4096
  buffer_load_dwordx4 v[144:147], v197, s[48:51], s38 offen offset:2048 sc1
  s_waitcnt vmcnt(9)
  v_mfma_f32_16x16x32_bf16 v[48:51], v[68:71], v[172:175], v[48:51]
  ds_read_b64_tr_b16 v[84:85], v106 offset:8192
  v_mfma_f32_16x16x32_bf16 v[48:51], v[64:67], v[164:167], v[48:51]
  ds_read_b64_tr_b16 v[86:87], v118 offset:8192
  s_waitcnt lgkmcnt(6)
  v_mfma_f32_16x16x32_bf16 v[52:55], v[72:75], v[164:167], v[52:55]
  ds_read_b64_tr_b16 v[88:89], v107 offset:4096
  s_waitcnt lgkmcnt(5)
  v_mfma_f32_16x16x32_bf16 v[52:55], v[76:79], v[172:175], v[52:55]
  ds_read_b64_tr_b16 v[90:91], v119 offset:4096
  buffer_load_dwordx4 v[148:151], v197, s[48:51], s39 offen offset:2048 sc1
  v_mfma_f32_16x16x32_bf16 v[36:39], v[76:79], v[168:171], v[36:39]
  ds_read_b64_tr_b16 v[92:93], v107 offset:8192
  v_mfma_f32_16x16x32_bf16 v[36:39], v[72:75], v[160:163], v[36:39]
  ds_read_b64_tr_b16 v[94:95], v119 offset:8192
  s_waitcnt lgkmcnt(6)
  v_mfma_f32_16x16x32_bf16 v[40:43], v[80:83], v[160:163], v[40:43]
  ds_read_b64_tr_b16 v[64:65], v104 offset:12288
  s_waitcnt lgkmcnt(5)
  v_mfma_f32_16x16x32_bf16 v[40:43], v[84:87], v[168:171], v[40:43]
  ds_read_b64_tr_b16 v[66:67], v116 offset:12288
  buffer_load_dwordx4 v[152:155], v197, s[48:51], s38 offen offset:3072 sc1
  v_mfma_f32_16x16x32_bf16 v[56:59], v[84:87], v[172:175], v[56:59]
  ds_read_b64_tr_b16 v[68:69], v104 offset:16384
  v_mfma_f32_16x16x32_bf16 v[56:59], v[80:83], v[164:167], v[56:59]
  ds_read_b64_tr_b16 v[70:71], v116 offset:16384
  s_waitcnt lgkmcnt(6)
  v_mfma_f32_16x16x32_bf16 v[60:63], v[88:91], v[164:167], v[60:63]
  ds_read_b64_tr_b16 v[72:73], v105 offset:12288
  s_waitcnt lgkmcnt(5)
  v_mfma_f32_16x16x32_bf16 v[60:63], v[92:95], v[172:175], v[60:63]
  ds_read_b64_tr_b16 v[74:75], v117 offset:12288
  buffer_load_dwordx4 v[156:159], v197, s[48:51], s39 offen offset:3072 sc1
  v_mfma_f32_16x16x32_bf16 v[44:47], v[92:95], v[168:171], v[44:47]
  ds_read_b64_tr_b16 v[76:77], v105 offset:16384
  v_mfma_f32_16x16x32_bf16 v[44:47], v[88:91], v[160:163], v[44:47]
  ds_read_b64_tr_b16 v[78:79], v117 offset:16384
  s_waitcnt vmcnt(11) lgkmcnt(6)
  v_mfma_f32_16x16x32_bf16 v[32:35], v[64:67], v[176:179], v[32:35]
  ds_read_b32 v3, v206 offset:52
  ds_read_b64_tr_b16 v[80:81], v106 offset:12288
  s_xor_b32 s38, s38, 4096
L_pad_6:
  s_cmp_eq_u32 s101, 1
  s_cbranch_scc1 L_res_h
  s_xor_b32 s39, s39, 4096
  s_waitcnt vmcnt(9) lgkmcnt(6)
  v_mfma_f32_16x16x32_bf16 v[32:35], v[68:71], v[184:187], v[32:35]
  ds_read_b64_tr_b16 v[82:83], v118 offset:12288
  buffer_load_dwordx4 v[160:163], v197, s[48:51], s38 offen offset:0 sc1
  s_waitcnt vmcnt(9)
  v_mfma_f32_16x16x32_bf16 v[48:51], v[68:71], v[188:191], v[48:51]
  ds_read_b64_tr_b16 v[84:85], v106 offset:16384
  v_mfma_f32_16x16x32_bf16 v[48:51], v[64:67], v[180:183], v[48:51]
  ds_read_b64_tr_b16 v[86:87], v118 offset:16384
  s_waitcnt lgkmcnt(7)
  v_mfma_f32_16x16x32_bf16 v[52:55], v[72:75], v[180:183], v[52:55]
  ds_read_b64_tr_b16 v[88:89], v107 offset:12288
  s_waitcnt lgkmcnt(6)
  v_mfma_f32_16x16x32_bf16 v[52:55], v[76:79], v[188:191], v[52:55]
  ds_read_b64_tr_b16 v[90:91], v119 offset:12288
  buffer_load_dwordx4 v[164:167], v197, s[48:51], s39 offen offset:0 sc1
  v_mfma_f32_16x16x32_bf16 v[36:39], v[76:79], v[184:187], v[36:39]
  ds_read_b64_tr_b16 v[92:93], v107 offset:16384
  s_waitcnt lgkmcnt(7)
  v_cmp_ne_u32 vcc, 4, v3
  v_mfma_f32_16x16x32_bf16 v[36:39], v[72:75], v[176:179], v[36:39]
  ds_read_b64_tr_b16 v[94:95], v119 offset:16384
  s_cbranch_vccnz L_wf_33
L_wf_33r:
  s_waitcnt lgkmcnt(6)
  v_mfma_f32_16x16x32_bf16 v[40:43], v[80:83], v[176:179], v[40:43]
  ds_read_b64_tr_b16 v[64:65], v100 offset:0
  s_waitcnt lgkmcnt(5)
  v_mfma_f32_16x16x32_bf16 v[40:43], v[84:87], v[184:187], v[40:43]
  ds_read_b64_tr_b16 v[66:67], v112 offset:0
  buffer_load_dwordx4 v[168:171], v197, s[48:51], s38 offen offset:1024 sc1
  v_mfma_f32_16x16x32_bf16 v[56:59], v[84:87], v[188:191], v[56:59]
  ds_read_b64_tr_b16 v[68:69], v100 offset:8704
  v_mfma_f32_16x16x32_bf16 v[56:59], v[80:83], v[180:183], v[56:59]
  ds_read_b64_tr_b16 v[70:71], v112 offset:8704
  s_waitcnt lgkmcnt(6)
  v_mfma_f32_16x16x32_bf16 v[60:63], v[88:91], v[180:183], v[60:63]
  ds_read_b64_tr_b16 v[72:73], v101 offset:0
  s_waitcnt lgkmcnt(5)
  v_mfma_f32_16x16x32_bf16 v[60:63], v[92:95], v[188:191], v[60:63]
  ds_read_b64_tr_b16 v[74:75], v113 offset:0
  buffer_load_dwordx4 v[172:175], v197, s[48:51], s39 offen offset:1024 sc1
  v_mfma_f32_16x16x32_bf16 v[44:47], v[92:95], v[184:187], v[44:47]
  ds_read_b64_tr_b16 v[76:77], v101 offset:8704
  v_mfma_f32_16x16x32_bf16 v[44:47], v[88:91], v[176:179], v[44:47]
  ds_read_b64_tr_b16 v[78:79], v113 offset:8704
  s_waitcnt vmcnt(11) lgkmcnt(6)
  v_mfma_f32_16x16x32_bf16 v[32:35], v[64:67], v[128:131], v[32:35]
  ds_read_b64_tr_b16 v[80:81], v102 offset:0
  s_waitcnt vmcnt(9) lgkmcnt(5)
  v_mfma_f32_16x16x32_bf16 v[32:35], v[68:71], v[136:139], v[32:35]
  ds_read_b64_tr_b16 v[82:83], v114 offset:0
  buffer_load_dwordx4 v[176:179], v197, s[48:51], s38 offen offset:2048 sc1
  s_waitcnt vmcnt(9)
  v_mfma_f32_16x16x32_bf16 v[48:51], v[68:71], v[140:143], v[48:51]
  ds_read_b64_tr_b16 v[84:85], v102 offset:8704
  v_mfma_f32_16x16x32_bf16 v[48:51], v[64:67], v[132:135], v[48:51]
  ds_read_b64_tr_b16 v[86:87], v114 offset:8704
  s_waitcnt lgkmcnt(6)
  v_mfma_f32_16x16x32_bf16 v[52:55], v[72:75], v[132:135], v[52:55]
  ds_read_b64_tr_b16 v[88:89], v103 offset:0
  s_waitcnt lgkmcnt(5)
  v_mfma_f32_16x16x32_bf16 v[52:55], v[76:79], v[140:143], v[52:55]
  ds_read_b64_tr_b16 v[90:91], v115 offset:0
  buffer_load_dwordx4 v[180:183], v197, s[48:51], s39 offen offset:2048 sc1
  v_mfma_f32_16x16x32_bf16 v[36:39], v[76:79], v[136:139], v[36:39]
  ds_read_b64_tr_b16 v[92:93], v103 offset:8704
  v_mfma_f32_16x16x32_bf16 v[36:39], v[72:75], v[128:131], v[36:39]
  ds_read_b64_tr_b16 v[94:95], v115 offset:8704
  s_waitcnt lgkmcnt(6)
  v_mfma_f32_16x16x32_bf16 v[40:43], v[80:83], v[128:131], v[40:43]
  ds_read_b64_tr_b16 v[64:65], v100 offset:17408
  s_waitcnt lgkmcnt(5)
  v_mfma_f32_16x16x32_bf16 v[40:43], v[84:87], v[136:139], v[40:43]
  ds_read_b64_tr_b16 v[66:67], v112 offset:17408
  buffer_load_dwordx4 v[184:187], v197, s[48:51], s38 offen offset:3072 sc1
  v_mfma_f32_16x16x32_bf16 v[56:59], v[84:87], v[140:143], v[56:59]
  ds_read_b64_tr_b16 v[68:69], v100 offset:26112
  v_mfma_f32_16x16x32_bf16 v[56:59], v[80:83], v[132:135], v[56:59]
  ds_read_b64_tr_b16 v[70:71], v112 offset:26112
  s_waitcnt lgkmcnt(6)
  v_mfma_f32_16x16x32_bf16 v[60:63], v[88:91], v[132:135], v[60:63]
  ds_read_b64_tr_b16 v[72:73], v101 offset:17408
  s_waitcnt lgkmcnt(5)
  v_mfma_f32_16x16x32_bf16 v[60:63], v[92:95], v[140:143], v[60:63]
  ds_read_b64_tr_b16 v[74:75], v113 offset:17408
  buffer_load_dwordx4 v[188:191], v197, s[48:51], s39 offen offset:3072 sc1
  v_mfma_f32_16x16x32_bf16 v[44:47], v[92:95], v[136:139], v[44:47]
  ds_read_b64_tr_b16 v[76:77], v101 offset:26112
  v_mfma_f32_16x16x32_bf16 v[44:47], v[88:91], v[128:131], v[44:47]
  ds_read_b64_tr_b16 v[78:79], v113 offset:26112
  s_waitcnt vmcnt(11) lgkmcnt(6)
  v_mfma_f32_16x16x32_bf16 v[32:35], v[64:67], v[144:147], v[32:35]
  ds_read_b64_tr_b16 v[80:81], v102 offset:17408
  s_waitcnt vmcnt(9) lgkmcnt(5)
  v_mfma_f32_16x16x32_bf16 v[32:35], v[68:71], v[152:155], v[32:35]
  ds_read_b64_tr_b16 v[82:83], v114 offset:17408
  s_waitcnt vmcnt(8)
  v_mfma_f32_16x16x32_bf16 v[48:51], v[68:71], v[156:159], v[48:51]
  ds_read_b64_tr_b16 v[84:85], v102 offset:26112
  v_mfma_f32_16x16x32_bf16 v[48:51], v[64:67], v[148:151], v[48:51]
  ds_read_b64_tr_b16 v[86:87], v114 offset:26112
  s_waitcnt lgkmcnt(6)
  v_mfma_f32_16x16x32_bf16 v[52:55], v[72:75], v[148:151], v[52:55]
  ds_read_b64_tr_b16 v[88:89], v103 offset:17408
  s_waitcnt lgkmcnt(5)
  v_mfma_f32_16x16x32_bf16 v[52:55], v[76:79], v[156:159], v[52:55]
  ds_read_b64_tr_b16 v[90:91], v115 offset:17408
  v_mfma_f32_16x16x32_bf16 v[36:39], v[76:79], v[152:155], v[36:39]
  ds_read_b64_tr_b16 v[92:93], v103 offset:26112
  v_mfma_f32_16x16x32_bf16 v[36:39], v[72:75], v[144:147], v[36:39]
  ds_read_b64_tr_b16 v[94:95], v115 offset:26112
  s_waitcnt lgkmcnt(6)
  v_mfma_f32_16x16x32_bf16 v[40:43], v[80:83], v[144:147], v[40:43]
  ds_read_b64_tr_b16 v[64:65], v100 offset:4096
  s_waitcnt lgkmcnt(5)
  v_mfma_f32_16x16x32_bf16 v[40:43], v[84:87], v[152:155], v[40:43]
  ds_read_b64_tr_b16 v[66:67], v112 offset:4096
  v_mfma_f32_16x16x32_bf16 v[56:59], v[84:87], v[156:159], v[56:59]
  ds_read_b64_tr_b16 v[68:69], v100 offset:12800
  v_mfma_f32_16x16x32_bf16 v[56:59], v[80:83], v[148:151], v[56:59]
  ds_read_b64_tr_b16 v[70:71], v112 offset:12800
  s_waitcnt lgkmcnt(6)
  v_mfma_f32_16x16x32_bf16 v[60:63], v[88:91], v[148:151], v[60:63]
  ds_read_b64_tr_b16 v[72:73], v101 offset:4096
  s_waitcnt lgkmcnt(5)
  v_mfma_f32_16x16x32_bf16 v[60:63], v[92:95], v[156:159], v[60:63]
  ds_read_b64_tr_b16 v[74:75], v113 offset:4096
  v_mfma_f32_16x16x32_bf16 v[44:47], v[92:95], v[152:155], v[44:47]
  ds_read_b64_tr_b16 v[76:77], v101 offset:12800
  v_mfma_f32_16x16x32_bf16 v[44:47], v[88:91], v[144:147], v[44:47]
  ds_read_b64_tr_b16 v[78:79], v113 offset:12800
  s_waitcnt vmcnt(7) lgkmcnt(6)
  v_mfma_f32_16x16x32_bf16 v[32:35], v[64:67], v[160:163], v[32:35]
  ds_read_b64_tr_b16 v[80:81], v102 offset:4096
  s_waitcnt vmcnt(5) lgkmcnt(5)
  v_mfma_f32_16x16x32_bf16 v[32:35], v[68:71], v[168:171], v[32:35]
  ds_read_b64_tr_b16 v[82:83], v114 offset:4096
  s_waitcnt vmcnt(4)
  v_mfma_f32_16x16x32_bf16 v[48:51], v[68:71], v[172:175], v[48:51]
  ds_read_b64_tr_b16 v[84:85], v102 offset:12800
  v_mfma_f32_16x16x32_bf16 v[48:51], v[64:67], v[164:167], v[48:51]
  ds_read_b64_tr_b16 v[86:87], v114 offset:12800
  s_waitcnt lgkmcnt(6)
  v_mfma_f32_16x16x32_bf16 v[52:55], v[72:75], v[164:167], v[52:55]
  ds_read_b64_tr_b16 v[88:89], v103 offset:4096
  s_waitcnt lgkmcnt(5)
  v_mfma_f32_16x16x32_bf16 v[52:55], v[76:79], v[172:175], v[52:55]
  ds_read_b64_tr_b16 v[90:91], v115 offset:4096
  v_mfma_f32_16x16x32_bf16 v[36:39], v[76:79], v[168:171], v[36:39]
  ds_read_b64_tr_b16 v[92:93], v103 offset:12800
  v_mfma_f32_16x16x32_bf16 v[36:39], v[72:75], v[160:163], v[36:39]
  ds_read_b64_tr_b16 v[94:95], v115 offset:12800
  s_waitcnt lgkmcnt(6)
  v_mfma_f32_16x16x32_bf16 v[40:43], v[80:83], v[160:163], v[40:43]
  ds_read_b64_tr_b16 v[64:65], v100 offset:21504
  s_waitcnt lgkmcnt(5)
  v_mfma_f32_16x16x32_bf16 v[40:43], v[84:87], v[168:171], v[40:43]
  ds_read_b64_tr_b16 v[66:67], v112 offset:21504
  v_mfma_f32_16x16x32_bf16 v[56:59], v[84:87], v[172:175], v[56:59]
  ds_read_b64_tr_b16 v[68:69], v100 offset:30208
  v_mfma_f32_16x16x32_bf16 v[56:59], v[80:83], v[164:167], v[56:59]
  ds_read_b64_tr_b16 v[70:71], v112 offset:30208
  s_waitcnt lgkmcnt(6)
  v_mfma_f32_16x16x32_bf16 v[60:63], v[88:91], v[164:167], v[60:63]
  ds_read_b64_tr_b16 v[72:73], v101 offset:21504
  s_waitcnt lgkmcnt(5)
  v_mfma_f32_16x16x32_bf16 v[60:63], v[92:95], v[172:175], v[60:63]
  ds_read_b64_tr_b16 v[74:75], v113 offset:21504
  v_mfma_f32_16x16x32_bf16 v[44:47], v[92:95], v[168:171], v[44:47]
  ds_read_b64_tr_b16 v[76:77], v101 offset:30208
  v_mfma_f32_16x16x32_bf16 v[44:47], v[88:91], v[160:163], v[44:47]
  ds_read_b64_tr_b16 v[78:79], v113 offset:30208
  s_waitcnt vmcnt(3) lgkmcnt(6)
  v_mfma_f32_16x16x32_bf16 v[32:35], v[64:67], v[176:179], v[32:35]
  ds_read_b64_tr_b16 v[80:81], v102 offset:21504
  ds_read_b64_tr_b16 v[82:83], v114 offset:21504
  s_waitcnt vmcnt(1) lgkmcnt(6)
  v_mfma_f32_16x16x32_bf16 v[32:35], v[68:71], v[184:187], v[32:35]
  ds_read_b64_tr_b16 v[84:85], v102 offset:30208
  ds_read_b64_tr_b16 v[86:87], v114 offset:30208
  s_waitcnt lgkmcnt(4)
  v_mfma_f32_16x16x32_bf16 v[36:39], v[76:79], v[184:187], v[36:39]
  ds_read_b64_tr_b16 v[88:89], v103 offset:21504
  ds_read_b64_tr_b16 v[90:91], v115 offset:21504
  v_mfma_f32_16x16x32_bf16 v[36:39], v[72:75], v[176:179], v[36:39]
  ds_read_b64_tr_b16 v[92:93], v103 offset:30208
  ds_read_b64_tr_b16 v[94:95], v115 offset:30208
  s_waitcnt lgkmcnt(6)
  v_mfma_f32_16x16x32_bf16 v[40:43], v[80:83], v[176:179], v[40:43]
  s_waitcnt lgkmcnt(4)
  v_mfma_f32_16x16x32_bf16 v[40:43], v[84:87], v[184:187], v[40:43]
  s_waitcnt lgkmcnt(0)
  v_mfma_f32_16x16x32_bf16 v[44:47], v[92:95], v[184:187], v[44:47]
  v_mfma_f32_16x16x32_bf16 v[44:47], v[88:91], v[176:179], v[44:47]
  v_mfma_f32_16x16x32_bf16 v[48:51], v[64:67], v[180:183], v[48:51]
  s_waitcnt vmcnt(0)
  v_mfma_f32_16x16x32_bf16 v[48:51], v[68:71], v[188:191], v[48:51]
  v_cvt_pk_bf16_f32 v208, v32, v33
  v_cvt_pk_bf16_f32 v209, v34, v35
  v_mfma_f32_16x16x32_bf16 v[52:55], v[76:79], v[188:191], v[52:55]
  ds_write_b64 v9, v[208:209]
  v_cvt_pk_bf16_f32 v210, v36, v37
  v_mfma_f32_16x16x32_bf16 v[52:55], v[72:75], v[180:183], v[52:55]
  v_cvt_pk_bf16_f32 v211, v38, v39
  ds_write_b64 v10, v[210:211]
  v_mfma_f32_16x16x32_bf16 v[56:59], v[80:83], v[180:183], v[56:59]
  v_cvt_pk_bf16_f32 v212, v40, v41
  v_cvt_pk_bf16_f32 v213, v42, v43
  v_mfma_f32_16x16x32_bf16 v[56:59], v[84:87], v[188:191], v[56:59]
  ds_write_b64 v11, v[212:213]
  v_cvt_pk_bf16_f32 v214, v44, v45
  v_mfma_f32_16x16x32_bf16 v[60:63], v[92:95], v[188:191], v[60:63]
  v_cvt_pk_bf16_f32 v215, v46, v47
  ds_write_b64 v12, v[214:215]
  v_mfma_f32_16x16x32_bf16 v[60:63], v[88:91], v[180:183], v[60:63]
  ds_read_b128 v[240:243], v13 offset:0
  ds_read_b128 v[244:247], v13 offset:1024
  v_cvt_pk_bf16_f32 v216, v48, v49
  v_cvt_pk_bf16_f32 v217, v50, v51
  ds_write_b64 v9, v[216:217]
  v_cvt_pk_bf16_f32 v218, v52, v53
  v_cvt_pk_bf16_f32 v219, v54, v55
  ds_write_b64 v10, v[218:219]
  s_waitcnt lgkmcnt(3)
  buffer_store_dwordx4 v[240:243], v8, s[52:55], s93 offen nt
  s_add_u32 s93, s93, 32768
  v_cvt_pk_bf16_f32 v220, v56, v57
  v_cvt_pk_bf16_f32 v221, v58, v59
  ds_write_b64 v11, v[220:221]
  v_cvt_pk_bf16_f32 v222, v60, v61
  v_cvt_pk_bf16_f32 v223, v62, v63
  ds_write_b64 v12, v[222:223]
  ds_read_b128 v[248:251], v13 offset:0
  ds_read_b128 v[252:255], v13 offset:1024
  s_waitcnt lgkmcnt(6)
  buffer_store_dwordx4 v[244:247], v8, s[52:55], s93 offen nt
  s_add_u32 s93, s93, 32768
  s_waitcnt lgkmcnt(1)
  buffer_store_dwordx4 v[248:251], v8, s[52:55], s93 offen nt
  s_add_u32 s93, s93, 32768
  s_waitcnt lgkmcnt(0)
  buffer_store_dwordx4 v[252:255], v8, s[52:55], s93 offen nt
L_end:
  s_endpgm
L_zretry:
  s_sub_u32 s97, s97, 1
  s_cbranch_scc1 L_zok
  buffer_load_dwordx4 v[40:43], v197, s[48:51], s94 offen offset:0 sc1
  buffer_load_dwordx4 v[44:47], v197, s[48:51], s94 offen offset:1024 sc1
  s_waitcnt vmcnt(0)
  s_branch L_zchk
L_kretry:
  s_sub_u32 s97, s97, 1
  s_cmp_lt_i32 s97, 0
  s_cbranch_scc1 L_kok
  s_xor_b32 s96, s96, 12288
  buffer_load_dwordx4 v[132:135], v197, s[48:51], s96 offen offset:0 sc1
  buffer_load_dwordx4 v[136:139], v197, s[48:51], s96 offen offset:1024 sc1
  buffer_load_dwordx4 v[140:143], v197, s[48:51], s96 offen offset:2048 sc1
  buffer_load_dwordx4 v[144:147], v197, s[48:51], s96 offen offset:3072 sc1
  s_xor_b32 s96, s96, 4096
  buffer_load_dwordx4 v[148:151], v197, s[48:51], s96 offen offset:0 sc1
  buffer_load_dwordx4 v[152:155], v197, s[48:51], s96 offen offset:1024 sc1
  buffer_load_dwordx4 v[156:159], v197, s[48:51], s96 offen offset:2048 sc1
  buffer_load_dwordx4 v[160:163], v197, s[48:51], s96 offen offset:3072 sc1
  s_xor_b32 s96, s96, 12288
  buffer_load_dwordx4 v[164:167], v197, s[48:51], s96 offen offset:0 sc1
  buffer_load_dwordx4 v[168:171], v197, s[48:51], s96 offen offset:1024 sc1
  buffer_load_dwordx4 v[172:175], v197, s[48:51], s96 offen offset:2048 sc1
  buffer_load_dwordx4 v[176:179], v197, s[48:51], s96 offen offset:3072 sc1
  s_xor_b32 s96, s96, 4096
  buffer_load_dwordx4 v[180:183], v197, s[48:51], s96 offen offset:0 sc1
  buffer_load_dwordx4 v[184:187], v197, s[48:51], s96 offen offset:1024 sc1
  buffer_load_dwordx4 v[188:191], v197, s[48:51], s96 offen offset:2048 sc1
  buffer_load_dwordx4 v[192:195], v197, s[48:51], s96 offen offset:3072 sc1
  v_mov_b32_e64 v12, 0
  s_waitcnt vmcnt(15)
  v_mfma_f32_16x16x32_bf16 v[56:59], v[210:213], v[132:135], 0
  v_mfma_f32_16x16x32_bf16 v[60:63], v[208:211], v[132:135], 0
  v_max3_u32 v12, v12, v132, v133
  v_max3_u32 v12, v12, v134, v135
  s_waitcnt vmcnt(14)
  v_mfma_f32_16x16x32_bf16 v[56:59], v[210:213], v[136:139], v[56:59]
  v_mfma_f32_16x16x32_bf16 v[60:63], v[208:211], v[136:139], v[60:63]
  v_max3_u32 v12, v12, v136, v137
  v_max3_u32 v12, v12, v138, v139
  s_waitcnt vmcnt(13)
  v_mfma_f32_16x16x32_bf16 v[56:59], v[210:213], v[140:143], v[56:59]
  v_mfma_f32_16x16x32_bf16 v[60:63], v[208:211], v[140:143], v[60:63]
  v_max3_u32 v12, v12, v140, v141
  v_max3_u32 v12, v12, v142, v143
  s_waitcnt vmcnt(12)
  v_mfma_f32_16x16x32_bf16 v[56:59], v[210:213], v[144:147], v[56:59]
  v_mfma_f32_16x16x32_bf16 v[60:63], v[208:211], v[144:147], v[60:63]
  v_max3_u32 v12, v12, v144, v145
  v_max3_u32 v12, v12, v146, v147
  s_waitcnt vmcnt(11)
  v_mfma_f32_16x16x32_bf16 v[56:59], v[210:213], v[148:151], v[56:59]
  v_mfma_f32_16x16x32_bf16 v[60:63], v[208:211], v[148:151], v[60:63]
  v_max3_u32 v12, v12, v148, v149
  v_max3_u32 v12, v12, v150, v151
  s_waitcnt vmcnt(10)
  v_mfma_f32_16x16x32_bf16 v[56:59], v[210:213], v[152:155], v[56:59]
  v_mfma_f32_16x16x32_bf16 v[60:63], v[208:211], v[152:155], v[60:63]
  v_max3_u32 v12, v12, v152, v153
  v_max3_u32 v12, v12, v154, v155
  s_waitcnt vmcnt(9)
  v_mfma_f32_16x16x32_bf16 v[56:59], v[210:213], v[156:159], v[56:59]
  v_mfma_f32_16x16x32_bf16 v[60:63], v[208:211], v[156:159], v[60:63]
  v_max3_u32 v12, v12, v156, v157
  v_max3_u32 v12, v12, v158, v159
  s_waitcnt vmcnt(8)
  v_mfma_f32_16x16x32_bf16 v[56:59], v[210:213], v[160:163], v[56:59]
  v_mfma_f32_16x16x32_bf16 v[60:63], v[208:211], v[160:163], v[60:63]
  v_max3_u32 v12, v12, v160, v161
  v_max3_u32 v12, v12, v162, v163
  s_waitcnt vmcnt(7)
  v_mfma_f32_16x16x32_bf16 v[56:59], v[210:213], v[164:167], v[56:59]
  v_mfma_f32_16x16x32_bf16 v[60:63], v[208:211], v[164:167], v[60:63]
  v_max3_u32 v12, v12, v164, v165
  v_max3_u32 v12, v12, v166, v167
  s_waitcnt vmcnt(6)
  v_mfma_f32_16x16x32_bf16 v[56:59], v[210:213], v[168:171], v[56:59]
  v_mfma_f32_16x16x32_bf16 v[60:63], v[208:211], v[168:171], v[60:63]
  v_max3_u32 v12, v12, v168, v169
  v_max3_u32 v12, v12, v170, v171
  s_waitcnt vmcnt(5)
  v_mfma_f32_16x16x32_bf16 v[56:59], v[210:213], v[172:175], v[56:59]
  v_mfma_f32_16x16x32_bf16 v[60:63], v[208:211], v[172:175], v[60:63]
  v_max3_u32 v12, v12, v172, v173
  v_max3_u32 v12, v12, v174, v175
  s_waitcnt vmcnt(4)
  v_mfma_f32_16x16x32_bf16 v[56:59], v[210:213], v[176:179], v[56:59]
  v_mfma_f32_16x16x32_bf16 v[60:63], v[208:211], v[176:179], v[60:63]
  v_max3_u32 v12, v12, v176, v177
  v_max3_u32 v12, v12, v178, v179
  s_waitcnt vmcnt(3)
  v_mfma_f32_16x16x32_bf16 v[56:59], v[210:213], v[180:183], v[56:59]
  v_mfma_f32_16x16x32_bf16 v[60:63], v[208:211], v[180:183], v[60:63]
  v_max3_u32 v12, v12, v180, v181
  v_max3_u32 v12, v12, v182, v183
  s_waitcnt vmcnt(2)
  v_mfma_f32_16x16x32_bf16 v[56:59], v[210:213], v[184:187], v[56:59]
  v_mfma_f32_16x16x32_bf16 v[60:63], v[208:211], v[184:187], v[60:63]
  v_max3_u32 v12, v12, v184, v185
  v_max3_u32 v12, v12, v186, v187
  s_waitcnt vmcnt(1)
  v_mfma_f32_16x16x32_bf16 v[56:59], v[210:213], v[188:191], v[56:59]
  v_mfma_f32_16x16x32_bf16 v[60:63], v[208:211], v[188:191], v[60:63]
  v_max3_u32 v12, v12, v188, v189
  v_max3_u32 v12, v12, v190, v191
  s_waitcnt vmcnt(0)
  v_mfma_f32_16x16x32_bf16 v[56:59], v[210:213], v[192:195], v[56:59]
  v_mfma_f32_16x16x32_bf16 v[60:63], v[208:211], v[192:195], v[60:63]
  v_max3_u32 v12, v12, v192, v193
  v_max3_u32 v12, v12, v194, v195
  s_branch L_kchk
L_wf_32:
  ds_read_b32 v3, v206 offset:48
  s_waitcnt lgkmcnt(0)
  v_cmp_ne_u32_e64 vcc, 4, v3
  s_nop 0
  s_cbranch_vccnz L_wf_32
  s_branch L_wf_32r
L_wf_33:
  ds_read_b32 v3, v206 offset:52
  s_waitcnt lgkmcnt(0)
  v_cmp_ne_u32 vcc, 4, v3
  s_nop 0
  s_cbranch_vccnz L_wf_33
  s_branch L_wf_33r
.section .rodata,"a"
.p2align 6
.amdhsa_kernel concat_heads__linear_attn_block__ssm_conv_s4__prompt_kernel
  .amdhsa_next_free_vgpr 256
  .amdhsa_next_free_sgpr 102
  .amdhsa_accum_offset 256
  .amdhsa_group_segment_fixed_size 0
  .amdhsa_kernarg_size 120
  .amdhsa_user_sgpr_count 2
  .amdhsa_user_sgpr_kernarg_segment_ptr 1
  .amdhsa_system_sgpr_workgroup_id_x 1
.end_amdhsa_kernel
```
